```python
import torch

def _softmax(x, axis=-1):
    return torch.softmax(x, dim=axis)
def _gelu(x):
    return torch.nn.functional.gelu(x, approximate="tanh")
def _silu(x):
    return torch.nn.functional.silu(x)
def _sigmoid(x):
    return torch.sigmoid(x)
def _layernorm(x, axis=-1, eps=1e-5):
    m = x.mean(dim=axis, keepdim=True)
    v = x.var(dim=axis, keepdim=True, unbiased=False)
    return (x - m) / torch.sqrt(v + eps)
def _scatter_add(tgt, idx, src, axis=0):
    return tgt.clone().index_add_(axis, idx, src)
def _segment_sum(src, seg, n):
    out = torch.zeros((n,) + src.shape[1:], dtype=src.dtype)
    return out.index_add_(0, seg, src)
def _pad(x, pw):
    flat = tuple(v for pair in reversed(pw) for v in pair)
    return torch.nn.functional.pad(x, flat)

kernel_name = 'sequential_preLN__grouped_kv_mqa__glu_gated_geglu__prompt'

def setup_inputs():

    _w = (lambda a: (lambda t: t.to(torch.bfloat16) if t.is_floating_point() else t)(torch.as_tensor(a)))
    def _A_setup():
        B, S, D, H = 1, 2048, 512, 32
        Dh = D // H
        return {
            "x": _w((lambda *s: torch.randn(*s, dtype=torch.bfloat16) * 0.05)(B, S, D)),
            "wq": _w((lambda *s: torch.randn(*s, dtype=torch.bfloat16) * 0.05)(D, H * Dh)),
            "wk": _w((lambda *s: torch.randn(*s, dtype=torch.bfloat16) * 0.05)(D, Dh)),
            "wv": _w((lambda *s: torch.randn(*s, dtype=torch.bfloat16) * 0.05)(D, Dh)),
            "wo": _w((lambda *s: torch.randn(*s, dtype=torch.bfloat16) * 0.05)(H * Dh, D)),
        }
    _A_in = _A_setup()

    def _B_setup():
        B, S, Dm, Df = 1, 2048, 512, 1792
        return {
            "x": _w((lambda *s: torch.randn(*s, dtype=torch.bfloat16) * 0.05)(B, S, Dm)),
            "w_gate": _w((lambda *s: torch.randn(*s, dtype=torch.bfloat16) * 0.4)(Dm, Df) * (Dm ** -0.5)),
            "w_up": _w((lambda *s: torch.randn(*s, dtype=torch.bfloat16) * 0.4)(Dm, Df) * (Dm ** -0.5)),
            "w_down": _w((lambda *s: torch.randn(*s, dtype=torch.bfloat16) * 0.4)(Df, Dm) * (Df ** -0.5)),
        }
    _B_in = _B_setup()

    return {
        "A_x": _A_in["x"],
        "A_wq": _A_in["wq"],
        "A_wk": _A_in["wk"],
        "A_wv": _A_in["wv"],
        "A_wo": _A_in["wo"],
        "B_x": _B_in["x"],
        "B_w_gate": _B_in["w_gate"],
        "B_w_up": _B_in["w_up"],
        "B_w_down": _B_in["w_down"],
    }

def reference(A_x, A_wq, A_wk, A_wv, A_wo, B_x, B_w_gate, B_w_up, B_w_down):
    def _A_ref(x, wq, wk, wv, wo):
        B, S, D = x.shape
        H = 32
        Dh = D // H
        q = (lambda x, *d: x.permute(*d))((x @ wq).reshape(B, S, H, Dh), 0, 2, 1, 3)
        k = x @ wk
        v = x @ wv
        scores = torch.einsum("bhqd,bkd->bhqk", q, k) * (Dh ** -0.5)
        p = _softmax(scores, axis=-1)
        o = torch.einsum("bhqk,bkd->bhqd", p, v)
        return (lambda x, *d: x.permute(*d))(o, 0, 2, 1, 3).reshape(B, S, H * Dh) @ wo

    def _B_ref(x, w_gate, w_up, w_down):
        g = torch.einsum("bsd,df->bsf", x, w_gate)
        u = torch.einsum("bsd,df->bsf", x, w_up)
        h = _gelu(g) * u
        return torch.einsum("bsf,fd->bsd", h, w_down)

    x = A_x
    h = x + _A_ref(_layernorm(x, axis=-1), A_wq, A_wk, A_wv, A_wo)
    h2 = h + _B_ref(_layernorm(h, axis=-1), B_w_gate, B_w_up, B_w_down)
    return h2
```

```asm
; @launch kernel=qkv_kernel grid=(320,1,1) block=(256,1,1) lds=81920
; @launch kernel=attn_kernel grid=(256,1,1) block=(512,1,1) lds=158048
; @launch kernel=wo_kernel grid=(256,1,1) block=(256,1,1) lds=131072
; @launch kernel=ffn_kernel grid=(224,1,1) block=(512,1,1) lds=156672
; @launch kernel=down_kernel grid=(256,1,1) block=(256,1,1) lds=131072
.amdgcn_target "amdgcn-amd-amdhsa--gfx950"
.text
.globl qkv_kernel
.p2align 8
.type qkv_kernel,@function
qkv_kernel:
    s_cmp_ge_u32 s2, 320
    s_cbranch_scc1 L_qkv_kernel_end
    s_load_dwordx4 s[4:7], s[0:1], 0
    s_load_dwordx4 s[32:35], s[0:1], 16
    s_load_dwordx2 s[36:37], s[0:1], 88
    v_and_b32 v4, 63, v0
    v_lshrrev_b32 v6, 6, v0
    v_and_b32 v5, 31, v0
    v_readfirstlane_b32 s20, v6
    v_bfe_u32 v7, v0, 5, 1
    s_waitcnt lgkmcnt(0)
    s_mov_b32 s8, s4
    s_mov_b32 s9, s5
    s_mov_b32 s10, 2097152
    s_mov_b32 s11, 0x00020000
    s_mov_b32 s12, s6
    s_mov_b32 s13, s7
    s_mov_b32 s14, 524288
    s_mov_b32 s15, 0x00020000
    s_mov_b32 s16, s36
    s_mov_b32 s17, s37
    s_mov_b32 s18, 268435456
    s_mov_b32 s19, 0x00020000
    v_mov_b32 v64, 0
    v_mov_b32 v80, 0
    v_mov_b32 v65, 0
    v_mov_b32 v81, 0
    v_mov_b32 v66, 0
    v_mov_b32 v82, 0
    v_mov_b32 v67, 0
    v_mov_b32 v83, 0
    v_mov_b32 v68, 0
    v_mov_b32 v84, 0
    v_mov_b32 v69, 0
    v_mov_b32 v85, 0
    v_mov_b32 v70, 0
    v_mov_b32 v86, 0
    v_mov_b32 v71, 0
    v_mov_b32 v87, 0
    v_mov_b32 v72, 0
    v_mov_b32 v88, 0
    v_mov_b32 v73, 0
    v_mov_b32 v89, 0
    v_mov_b32 v74, 0
    v_mov_b32 v90, 0
    v_mov_b32 v75, 0
    v_mov_b32 v91, 0
    v_mov_b32 v76, 0
    v_mov_b32 v92, 0
    v_mov_b32 v77, 0
    v_mov_b32 v93, 0
    v_mov_b32 v78, 0
    v_mov_b32 v94, 0
    v_mov_b32 v79, 0
    v_mov_b32 v95, 0
    v_mov_b32 v96, 0x3f803f80
    v_mov_b32 v97, 0x3f803f80
    v_mov_b32 v98, 0x3f803f80
    v_mov_b32 v99, 0x3f803f80
    v_mov_b32 v100, 0
    v_mov_b32 v101, 0
    v_mov_b32 v102, 0
    v_mov_b32 v103, 0
    v_mov_b32 v104, 0
    v_mov_b32 v105, 0
    v_mov_b32 v106, 0
    v_mov_b32 v107, 0
    s_cmp_lt_u32 s2, 64
    s_cbranch_scc1 L_qkv_kernel_kv
    s_sub_u32 s2, s2, 64
    s_and_b32 s21, s2, 7
    s_lshl_b32 s21, s21, 2
    s_lshr_b32 s22, s2, 6
    s_add_u32 s21, s21, s22
    s_lshl_b32 s21, s21, 6
    s_bfe_u32 s22, s2, 0x30003
    s_lshl_b32 s22, s22, 6
    s_and_b32 s23, s20, 1
    s_lshr_b32 s24, s20, 1
    v_lshrrev_b32 v10, 3, v4
    v_and_b32 v11, 7, v4
    v_lshrrev_b32 v12, 4, v4
    s_lshl_b32 s25, s20, 2
    v_add_u32 v12, s25, v12
    v_and_b32 v12, 7, v12
    v_xor_b32 v11, v11, v12
    s_mov_b32 s25, 1024
    v_mul_lo_u32 v10, v10, s25
    v_lshl_add_u32 v1, v11, 4, v10
    v_lshrrev_b32 v10, 3, v4
    v_and_b32 v11, 7, v4
    v_bfe_u32 v12, v4, 4, 1
    v_lshlrev_b32 v12, 2, v12
    v_xor_b32 v11, v11, v12
    s_mov_b32 s25, 1024
    v_mul_lo_u32 v10, v10, s25
    v_lshl_add_u32 v2, v11, 4, v10
    s_mul_i32 s25, s20, 8
    s_add_u32 s25, s25, s21
    s_mul_i32 s26, s25, 1024
    s_add_u32 s26, s26, 0
    s_mul_i32 s27, s20, 8192
    s_lshl_b32 s25, s22, 1
    s_add_u32 s27, s27, s25
    s_lshl_b32 s28, s20, 10
    s_mov_b32 s29, s28
    s_add_u32 s30, s28, 81920
    s_mov_b32 s46, 4
L_qkv_kernel_pre:
    s_add_u32 s38, s29, 0
    s_mov_b32 m0, s38
    s_add_u32 s39, s26, 0
    buffer_load_dwordx4 v1, s[8:11], s39 offen lds
    s_add_u32 s38, s29, 4096
    s_mov_b32 m0, s38
    s_add_u32 s39, s26, 32768
    buffer_load_dwordx4 v1, s[8:11], s39 offen lds
    s_add_u32 s38, s29, 8192
    s_mov_b32 m0, s38
    s_add_u32 s39, s27, 0
    buffer_load_dwordx4 v2, s[12:15], s39 offen lds
    s_add_u32 s38, s29, 12288
    s_mov_b32 m0, s38
    s_add_u32 s39, s27, 32768
    buffer_load_dwordx4 v2, s[12:15], s39 offen lds
    s_add_u32 s26, s26, 128
    s_add_u32 s27, s27, 65536
    s_add_u32 s29, s29, 16384
    s_cmp_ge_u32 s29, s30
    s_cselect_b32 s29, s28, s29
    s_sub_u32 s46, s46, 1
    s_cmp_lg_u32 s46, 0
    s_cbranch_scc1 L_qkv_kernel_pre
    v_bfe_u32 v10, v5, 1, 3
    v_xor_b32 v10, v10, v7
    v_lshlrev_b32 v10, 4, v10
    v_lshl_add_u32 v10, v5, 7, v10
    s_mul_i32 s25, s23, 4096
    v_xor_b32 v16, 0, v10
    v_add_u32 v16, s25, v16
    v_xor_b32 v17, 32, v10
    v_add_u32 v17, s25, v17
    v_xor_b32 v18, 64, v10
    v_add_u32 v18, s25, v18
    v_xor_b32 v19, 96, v10
    v_add_u32 v19, s25, v19
    v_bfe_u32 v10, v0, 2, 2
    v_lshl_add_u32 v11, v7, 3, v10
    v_lshlrev_b32 v11, 7, v11
    v_bfe_u32 v12, v0, 4, 1
    v_bfe_u32 v13, v0, 1, 1
    v_lshl_add_u32 v12, v12, 1, v13
    v_bfe_u32 v13, v0, 3, 1
    v_lshlrev_b32 v13, 2, v13
    v_xor_b32 v12, v12, v13
    v_lshl_add_u32 v11, v12, 4, v11
    v_and_b32 v13, 1, v0
    v_lshl_add_u32 v14, v13, 3, v11
    s_mul_i32 s25, s24, 1
    s_add_u32 s25, s25, 0
    s_lshl_b32 s25, s25, 6
    v_xor_b32 v32, s25, v14
    v_add_u32 v32, 8192, v32
    s_or_b32 s45, s21, s23
    v_mov_b32 v44, 0
    v_mov_b32 v45, 0
    v_mov_b32 v46, 0
    v_mov_b32 v47, 0
    v_mov_b32 v48, 0
    v_mov_b32 v49, 0
    v_mov_b32 v50, 0
    v_mov_b32 v51, 0
    s_mov_b32 s47, 0
    s_mov_b32 s46, 4
L_qkv_kernel_main:
    v_add_u32 v24, s47, v16
    v_add_u32 v25, s47, v17
    v_add_u32 v26, s47, v18
    v_add_u32 v27, s47, v19
    v_add_u32 v33, s47, v32
    s_add_u32 s47, s47, 16384
    s_cmp_ge_u32 s47, 81920
    s_cselect_b32 s47, 0, s47
    s_waitcnt vmcnt(12) lgkmcnt(0)
    s_barrier
    ds_read_b128 v[36:39], v24 offset:0
    ds_read_b64_tr_b16 v[40:41], v33 offset:0
    ds_read_b64_tr_b16 v[42:43], v33 offset:512
    v_mfma_f32_32x32x16_bf16 v[64:79], v[48:51], v[44:47], v[64:79]
    s_cmp_lg_u32 s45, 0
    s_cbranch_scc1 L_qkv_kernel_cs1
    v_mfma_f32_32x32x16_bf16 v[80:95], v[48:51], v[96:99], v[80:95]
L_qkv_kernel_cs1:
    s_add_u32 s38, s29, 0
    s_mov_b32 m0, s38
    s_add_u32 s39, s26, 0
    buffer_load_dwordx4 v1, s[8:11], s39 offen lds
    ds_read_b128 v[44:47], v25 offset:0
    ds_read_b64_tr_b16 v[48:49], v33 offset:2048
    ds_read_b64_tr_b16 v[50:51], v33 offset:2560
    s_waitcnt lgkmcnt(3)
    v_mfma_f32_32x32x16_bf16 v[64:79], v[40:43], v[36:39], v[64:79]
    s_cmp_lg_u32 s45, 0
    s_cbranch_scc1 L_qkv_kernel_cs2
    v_mfma_f32_32x32x16_bf16 v[80:95], v[40:43], v[96:99], v[80:95]
L_qkv_kernel_cs2:
    s_add_u32 s38, s29, 4096
    s_mov_b32 m0, s38
    s_add_u32 s39, s26, 32768
    buffer_load_dwordx4 v1, s[8:11], s39 offen lds
    ds_read_b128 v[36:39], v26 offset:0
    ds_read_b64_tr_b16 v[40:41], v33 offset:4096
    ds_read_b64_tr_b16 v[42:43], v33 offset:4608
    s_waitcnt lgkmcnt(3)
    v_mfma_f32_32x32x16_bf16 v[64:79], v[48:51], v[44:47], v[64:79]
    s_cmp_lg_u32 s45, 0
    s_cbranch_scc1 L_qkv_kernel_cs3
    v_mfma_f32_32x32x16_bf16 v[80:95], v[48:51], v[96:99], v[80:95]
L_qkv_kernel_cs3:
    s_add_u32 s38, s29, 8192
    s_mov_b32 m0, s38
    s_add_u32 s39, s27, 0
    buffer_load_dwordx4 v2, s[12:15], s39 offen lds
    ds_read_b128 v[44:47], v27 offset:0
    ds_read_b64_tr_b16 v[48:49], v33 offset:6144
    ds_read_b64_tr_b16 v[50:51], v33 offset:6656
    s_waitcnt lgkmcnt(3)
    v_mfma_f32_32x32x16_bf16 v[64:79], v[40:43], v[36:39], v[64:79]
    s_cmp_lg_u32 s45, 0
    s_cbranch_scc1 L_qkv_kernel_cs4
    v_mfma_f32_32x32x16_bf16 v[80:95], v[40:43], v[96:99], v[80:95]
L_qkv_kernel_cs4:
    s_add_u32 s38, s29, 12288
    s_mov_b32 m0, s38
    s_add_u32 s39, s27, 32768
    buffer_load_dwordx4 v2, s[12:15], s39 offen lds
    s_add_u32 s26, s26, 128
    s_add_u32 s27, s27, 65536
    s_add_u32 s29, s29, 16384
    s_cmp_ge_u32 s29, s30
    s_cselect_b32 s29, s28, s29
    s_sub_u32 s46, s46, 1
    s_cmp_lg_u32 s46, 0
    s_cbranch_scc1 L_qkv_kernel_main
    v_add_u32 v24, s47, v16
    v_add_u32 v25, s47, v17
    v_add_u32 v26, s47, v18
    v_add_u32 v27, s47, v19
    v_add_u32 v33, s47, v32
    s_add_u32 s47, s47, 16384
    s_cmp_ge_u32 s47, 81920
    s_cselect_b32 s47, 0, s47
    s_waitcnt vmcnt(12) lgkmcnt(0)
    s_barrier
    ds_read_b128 v[36:39], v24 offset:0
    ds_read_b64_tr_b16 v[40:41], v33 offset:0
    ds_read_b64_tr_b16 v[42:43], v33 offset:512
    v_mfma_f32_32x32x16_bf16 v[64:79], v[48:51], v[44:47], v[64:79]
    s_cmp_lg_u32 s45, 0
    s_cbranch_scc1 L_qkv_kernel_cs5
    v_mfma_f32_32x32x16_bf16 v[80:95], v[48:51], v[96:99], v[80:95]
L_qkv_kernel_cs5:
    ds_read_b128 v[44:47], v25 offset:0
    ds_read_b64_tr_b16 v[48:49], v33 offset:2048
    ds_read_b64_tr_b16 v[50:51], v33 offset:2560
    s_waitcnt lgkmcnt(3)
    v_mfma_f32_32x32x16_bf16 v[64:79], v[40:43], v[36:39], v[64:79]
    s_cmp_lg_u32 s45, 0
    s_cbranch_scc1 L_qkv_kernel_cs6
    v_mfma_f32_32x32x16_bf16 v[80:95], v[40:43], v[96:99], v[80:95]
L_qkv_kernel_cs6:
    ds_read_b128 v[36:39], v26 offset:0
    ds_read_b64_tr_b16 v[40:41], v33 offset:4096
    ds_read_b64_tr_b16 v[42:43], v33 offset:4608
    s_waitcnt lgkmcnt(3)
    v_mfma_f32_32x32x16_bf16 v[64:79], v[48:51], v[44:47], v[64:79]
    s_cmp_lg_u32 s45, 0
    s_cbranch_scc1 L_qkv_kernel_cs7
    v_mfma_f32_32x32x16_bf16 v[80:95], v[48:51], v[96:99], v[80:95]
L_qkv_kernel_cs7:
    ds_read_b128 v[44:47], v27 offset:0
    ds_read_b64_tr_b16 v[48:49], v33 offset:6144
    ds_read_b64_tr_b16 v[50:51], v33 offset:6656
    s_waitcnt lgkmcnt(3)
    v_mfma_f32_32x32x16_bf16 v[64:79], v[40:43], v[36:39], v[64:79]
    s_cmp_lg_u32 s45, 0
    s_cbranch_scc1 L_qkv_kernel_cs8
    v_mfma_f32_32x32x16_bf16 v[80:95], v[40:43], v[96:99], v[80:95]
L_qkv_kernel_cs8:
    v_add_u32 v24, s47, v16
    v_add_u32 v25, s47, v17
    v_add_u32 v26, s47, v18
    v_add_u32 v27, s47, v19
    v_add_u32 v33, s47, v32
    s_add_u32 s47, s47, 16384
    s_cmp_ge_u32 s47, 81920
    s_cselect_b32 s47, 0, s47
    s_waitcnt vmcnt(8) lgkmcnt(0)
    s_barrier
    ds_read_b128 v[36:39], v24 offset:0
    ds_read_b64_tr_b16 v[40:41], v33 offset:0
    ds_read_b64_tr_b16 v[42:43], v33 offset:512
    v_mfma_f32_32x32x16_bf16 v[64:79], v[48:51], v[44:47], v[64:79]
    s_cmp_lg_u32 s45, 0
    s_cbranch_scc1 L_qkv_kernel_cs9
    v_mfma_f32_32x32x16_bf16 v[80:95], v[48:51], v[96:99], v[80:95]
L_qkv_kernel_cs9:
    ds_read_b128 v[44:47], v25 offset:0
    ds_read_b64_tr_b16 v[48:49], v33 offset:2048
    ds_read_b64_tr_b16 v[50:51], v33 offset:2560
    s_waitcnt lgkmcnt(3)
    v_mfma_f32_32x32x16_bf16 v[64:79], v[40:43], v[36:39], v[64:79]
    s_cmp_lg_u32 s45, 0
    s_cbranch_scc1 L_qkv_kernel_cs10
    v_mfma_f32_32x32x16_bf16 v[80:95], v[40:43], v[96:99], v[80:95]
L_qkv_kernel_cs10:
    ds_read_b128 v[36:39], v26 offset:0
    ds_read_b64_tr_b16 v[40:41], v33 offset:4096
    ds_read_b64_tr_b16 v[42:43], v33 offset:4608
    s_waitcnt lgkmcnt(3)
    v_mfma_f32_32x32x16_bf16 v[64:79], v[48:51], v[44:47], v[64:79]
    s_cmp_lg_u32 s45, 0
    s_cbranch_scc1 L_qkv_kernel_cs11
    v_mfma_f32_32x32x16_bf16 v[80:95], v[48:51], v[96:99], v[80:95]
L_qkv_kernel_cs11:
    ds_read_b128 v[44:47], v27 offset:0
    ds_read_b64_tr_b16 v[48:49], v33 offset:6144
    ds_read_b64_tr_b16 v[50:51], v33 offset:6656
    s_waitcnt lgkmcnt(3)
    v_mfma_f32_32x32x16_bf16 v[64:79], v[40:43], v[36:39], v[64:79]
    s_cmp_lg_u32 s45, 0
    s_cbranch_scc1 L_qkv_kernel_cs12
    v_mfma_f32_32x32x16_bf16 v[80:95], v[40:43], v[96:99], v[80:95]
L_qkv_kernel_cs12:
    v_add_u32 v24, s47, v16
    v_add_u32 v25, s47, v17
    v_add_u32 v26, s47, v18
    v_add_u32 v27, s47, v19
    v_add_u32 v33, s47, v32
    s_add_u32 s47, s47, 16384
    s_cmp_ge_u32 s47, 81920
    s_cselect_b32 s47, 0, s47
    s_waitcnt vmcnt(4) lgkmcnt(0)
    s_barrier
    ds_read_b128 v[36:39], v24 offset:0
    ds_read_b64_tr_b16 v[40:41], v33 offset:0
    ds_read_b64_tr_b16 v[42:43], v33 offset:512
    v_mfma_f32_32x32x16_bf16 v[64:79], v[48:51], v[44:47], v[64:79]
    s_cmp_lg_u32 s45, 0
    s_cbranch_scc1 L_qkv_kernel_cs13
    v_mfma_f32_32x32x16_bf16 v[80:95], v[48:51], v[96:99], v[80:95]
L_qkv_kernel_cs13:
    ds_read_b128 v[44:47], v25 offset:0
    ds_read_b64_tr_b16 v[48:49], v33 offset:2048
    ds_read_b64_tr_b16 v[50:51], v33 offset:2560
    s_waitcnt lgkmcnt(3)
    v_mfma_f32_32x32x16_bf16 v[64:79], v[40:43], v[36:39], v[64:79]
    s_cmp_lg_u32 s45, 0
    s_cbranch_scc1 L_qkv_kernel_cs14
    v_mfma_f32_32x32x16_bf16 v[80:95], v[40:43], v[96:99], v[80:95]
L_qkv_kernel_cs14:
    ds_read_b128 v[36:39], v26 offset:0
    ds_read_b64_tr_b16 v[40:41], v33 offset:4096
    ds_read_b64_tr_b16 v[42:43], v33 offset:4608
    s_waitcnt lgkmcnt(3)
    v_mfma_f32_32x32x16_bf16 v[64:79], v[48:51], v[44:47], v[64:79]
    s_cmp_lg_u32 s45, 0
    s_cbranch_scc1 L_qkv_kernel_cs15
    v_mfma_f32_32x32x16_bf16 v[80:95], v[48:51], v[96:99], v[80:95]
L_qkv_kernel_cs15:
    ds_read_b128 v[44:47], v27 offset:0
    ds_read_b64_tr_b16 v[48:49], v33 offset:6144
    ds_read_b64_tr_b16 v[50:51], v33 offset:6656
    s_waitcnt lgkmcnt(3)
    v_mfma_f32_32x32x16_bf16 v[64:79], v[40:43], v[36:39], v[64:79]
    s_cmp_lg_u32 s45, 0
    s_cbranch_scc1 L_qkv_kernel_cs16
    v_mfma_f32_32x32x16_bf16 v[80:95], v[40:43], v[96:99], v[80:95]
L_qkv_kernel_cs16:
    v_add_u32 v24, s47, v16
    v_add_u32 v25, s47, v17
    v_add_u32 v26, s47, v18
    v_add_u32 v27, s47, v19
    v_add_u32 v33, s47, v32
    s_add_u32 s47, s47, 16384
    s_cmp_ge_u32 s47, 81920
    s_cselect_b32 s47, 0, s47
    s_waitcnt vmcnt(0) lgkmcnt(0)
    s_barrier
    ds_read_b128 v[36:39], v24 offset:0
    ds_read_b64_tr_b16 v[40:41], v33 offset:0
    ds_read_b64_tr_b16 v[42:43], v33 offset:512
    v_mfma_f32_32x32x16_bf16 v[64:79], v[48:51], v[44:47], v[64:79]
    s_cmp_lg_u32 s45, 0
    s_cbranch_scc1 L_qkv_kernel_cs17
    v_mfma_f32_32x32x16_bf16 v[80:95], v[48:51], v[96:99], v[80:95]
L_qkv_kernel_cs17:
    ds_read_b128 v[44:47], v25 offset:0
    ds_read_b64_tr_b16 v[48:49], v33 offset:2048
    ds_read_b64_tr_b16 v[50:51], v33 offset:2560
    s_waitcnt lgkmcnt(3)
    v_mfma_f32_32x32x16_bf16 v[64:79], v[40:43], v[36:39], v[64:79]
    s_cmp_lg_u32 s45, 0
    s_cbranch_scc1 L_qkv_kernel_cs18
    v_mfma_f32_32x32x16_bf16 v[80:95], v[40:43], v[96:99], v[80:95]
L_qkv_kernel_cs18:
    ds_read_b128 v[36:39], v26 offset:0
    ds_read_b64_tr_b16 v[40:41], v33 offset:4096
    ds_read_b64_tr_b16 v[42:43], v33 offset:4608
    s_waitcnt lgkmcnt(3)
    v_mfma_f32_32x32x16_bf16 v[64:79], v[48:51], v[44:47], v[64:79]
    s_cmp_lg_u32 s45, 0
    s_cbranch_scc1 L_qkv_kernel_cs19
    v_mfma_f32_32x32x16_bf16 v[80:95], v[48:51], v[96:99], v[80:95]
L_qkv_kernel_cs19:
    ds_read_b128 v[44:47], v27 offset:0
    ds_read_b64_tr_b16 v[48:49], v33 offset:6144
    ds_read_b64_tr_b16 v[50:51], v33 offset:6656
    s_waitcnt lgkmcnt(3)
    v_mfma_f32_32x32x16_bf16 v[64:79], v[40:43], v[36:39], v[64:79]
    s_cmp_lg_u32 s45, 0
    s_cbranch_scc1 L_qkv_kernel_cs20
    v_mfma_f32_32x32x16_bf16 v[80:95], v[40:43], v[96:99], v[80:95]
L_qkv_kernel_cs20:
    s_waitcnt lgkmcnt(0)
    v_mfma_f32_32x32x16_bf16 v[64:79], v[48:51], v[44:47], v[64:79]
    s_cmp_lg_u32 s45, 0
    s_cbranch_scc1 L_qkv_kernel_cs21
    v_mfma_f32_32x32x16_bf16 v[80:95], v[48:51], v[96:99], v[80:95]
L_qkv_kernel_cs21:
    s_nop 15
    s_lshl_b32 s25, s23, 5
    v_add_u32 v10, s25, v5
    s_movk_i32 s25, 272
    v_mul_lo_u32 v10, v10, s25
    v_lshl_add_u32 v10, v7, 4, v10
    s_lshl_b32 s25, s24, 7
    v_add_u32 v10, s25, v10
    ds_write_b128 v10, v[64:67] offset:0
    ds_write_b128 v10, v[68:71] offset:32
    ds_write_b128 v10, v[72:75] offset:64
    ds_write_b128 v10, v[76:79] offset:96
    v_lshrrev_b32 v3, 4, v0
    v_and_b32 v6, 15, v0
    s_movk_i32 s25, 272
    v_mul_lo_u32 v10, v3, s25
    v_lshl_add_u32 v10, v6, 4, v10
    v_lshlrev_b32 v3, 11, v3
    v_lshl_add_u32 v3, v6, 4, v3
    s_lshl_b32 s31, s21, 11
    s_lshl_b32 s25, s22, 2
    s_add_u32 s31, s31, s25
    s_add_u32 s31, s31, 20971520
    s_waitcnt lgkmcnt(0)
    s_barrier
    ds_read_b128 v[64:67], v10 offset:0
    ds_read_b128 v[68:71], v10 offset:4352
    ds_read_b128 v[72:75], v10 offset:8704
    ds_read_b128 v[76:79], v10 offset:13056
    s_waitcnt lgkmcnt(3)
    buffer_store_dwordx4 v[64:67], v3, s[16:19], s31 offen
    s_add_u32 s31, s31, 32768
    s_waitcnt lgkmcnt(2)
    buffer_store_dwordx4 v[68:71], v3, s[16:19], s31 offen
    s_add_u32 s31, s31, 32768
    s_waitcnt lgkmcnt(1)
    buffer_store_dwordx4 v[72:75], v3, s[16:19], s31 offen
    s_add_u32 s31, s31, 32768
    s_waitcnt lgkmcnt(0)
    buffer_store_dwordx4 v[76:79], v3, s[16:19], s31 offen
    s_cmp_lg_u32 s45, 0
    s_cbranch_scc1 L_qkv_kernel_end
    v_lshlrev_b32 v3, 4, v7
    s_lshl_b32 s25, s24, 5
    s_add_u32 s25, s25, s22
    s_lshl_b32 s25, s25, 2
    s_add_u32 s25, s25, 2252800
    buffer_store_dwordx4 v[80:83], v3, s[16:19], s25 offen offset:0
    buffer_store_dwordx4 v[84:87], v3, s[16:19], s25 offen offset:32
    buffer_store_dwordx4 v[88:91], v3, s[16:19], s25 offen offset:64
    buffer_store_dwordx4 v[92:95], v3, s[16:19], s25 offen offset:96
    s_branch L_qkv_kernel_end
L_qkv_kernel_kv:
    s_mov_b32 s40, s32
    s_mov_b32 s41, s33
    s_mov_b32 s42, 16384
    s_mov_b32 s43, 0x00020000
    s_mov_b32 s44, s34
    s_mov_b32 s45, s35
    s_mov_b32 s46, 16384
    s_mov_b32 s47, 0x00020000
    s_lshl_b32 s21, s2, 5
    s_add_u32 s2, s2, 256
    v_lshlrev_b32 v2, 4, v4
    s_lshl_b32 s25, s20, 3
    s_add_u32 s26, s25, s21
    s_lshl_b32 s26, s26, 10
    s_lshl_b32 s28, s20, 13
    s_lshl_b32 s29, s20, 12
    s_and_b32 s25, s25, 8
    s_add_u32 s38, s25, 0
    s_lshl_b32 s38, s38, 4
    v_xor_b32 v1, s38, v2
    s_add_u32 s38, s28, 0
    s_mov_b32 m0, s38
    s_add_u32 s39, s26, 0
    buffer_load_dwordx4 v1, s[8:11], s39 offen lds
    s_add_u32 s38, s25, 1
    s_lshl_b32 s38, s38, 4
    v_xor_b32 v1, s38, v2
    s_add_u32 s38, s28, 1024
    s_mov_b32 m0, s38
    s_add_u32 s39, s26, 1024
    buffer_load_dwordx4 v1, s[8:11], s39 offen lds
    s_add_u32 s38, s25, 2
    s_lshl_b32 s38, s38, 4
    v_xor_b32 v1, s38, v2
    s_add_u32 s38, s28, 2048
    s_mov_b32 m0, s38
    s_add_u32 s39, s26, 2048
    buffer_load_dwordx4 v1, s[8:11], s39 offen lds
    s_add_u32 s38, s25, 3
    s_lshl_b32 s38, s38, 4
    v_xor_b32 v1, s38, v2
    s_add_u32 s38, s28, 3072
    s_mov_b32 m0, s38
    s_add_u32 s39, s26, 3072
    buffer_load_dwordx4 v1, s[8:11], s39 offen lds
    s_add_u32 s38, s25, 4
    s_lshl_b32 s38, s38, 4
    v_xor_b32 v1, s38, v2
    s_add_u32 s38, s28, 4096
    s_mov_b32 m0, s38
    s_add_u32 s39, s26, 4096
    buffer_load_dwordx4 v1, s[8:11], s39 offen lds
    s_add_u32 s38, s25, 5
    s_lshl_b32 s38, s38, 4
    v_xor_b32 v1, s38, v2
    s_add_u32 s38, s28, 5120
    s_mov_b32 m0, s38
    s_add_u32 s39, s26, 5120
    buffer_load_dwordx4 v1, s[8:11], s39 offen lds
    s_add_u32 s38, s25, 6
    s_lshl_b32 s38, s38, 4
    v_xor_b32 v1, s38, v2
    s_add_u32 s38, s28, 6144
    s_mov_b32 m0, s38
    s_add_u32 s39, s26, 6144
    buffer_load_dwordx4 v1, s[8:11], s39 offen lds
    s_add_u32 s38, s25, 7
    s_lshl_b32 s38, s38, 4
    v_xor_b32 v1, s38, v2
    s_add_u32 s38, s28, 7168
    s_mov_b32 m0, s38
    s_add_u32 s39, s26, 7168
    buffer_load_dwordx4 v1, s[8:11], s39 offen lds
    s_add_u32 s39, s29, 0
    s_add_u32 s38, s39, 32768
    s_mov_b32 m0, s38
    s_nop 0
    buffer_load_dwordx4 v2, s[40:43], s39 offen lds
    s_add_u32 s38, s39, 49280
    s_mov_b32 m0, s38
    s_nop 0
    buffer_load_dwordx4 v2, s[44:47], s39 offen lds
    s_add_u32 s39, s29, 1024
    s_add_u32 s38, s39, 32768
    s_mov_b32 m0, s38
    s_nop 0
    buffer_load_dwordx4 v2, s[40:43], s39 offen lds
    s_add_u32 s38, s39, 49280
    s_mov_b32 m0, s38
    s_nop 0
    buffer_load_dwordx4 v2, s[44:47], s39 offen lds
    s_add_u32 s39, s29, 2048
    s_add_u32 s38, s39, 32768
    s_mov_b32 m0, s38
    s_nop 0
    buffer_load_dwordx4 v2, s[40:43], s39 offen lds
    s_add_u32 s38, s39, 49280
    s_mov_b32 m0, s38
    s_nop 0
    buffer_load_dwordx4 v2, s[44:47], s39 offen lds
    s_add_u32 s39, s29, 3072
    s_add_u32 s38, s39, 32768
    s_mov_b32 m0, s38
    s_nop 0
    buffer_load_dwordx4 v2, s[40:43], s39 offen lds
    s_add_u32 s38, s39, 49280
    s_mov_b32 m0, s38
    s_nop 0
    buffer_load_dwordx4 v2, s[44:47], s39 offen lds
    v_and_b32 v10, 15, v5
    v_xor_b32 v10, v10, v7
    v_lshlrev_b32 v10, 4, v10
    v_lshl_add_u32 v10, v5, 10, v10
    s_lshl_b32 s25, s20, 8
    v_xor_b32 v16, 0, v10
    v_add_u32 v16, s25, v16
    v_xor_b32 v17, 32, v10
    v_add_u32 v17, s25, v17
    v_xor_b32 v18, 64, v10
    v_add_u32 v18, s25, v18
    v_xor_b32 v19, 96, v10
    v_add_u32 v19, s25, v19
    v_xor_b32 v20, 128, v10
    v_add_u32 v20, s25, v20
    v_xor_b32 v21, 160, v10
    v_add_u32 v21, s25, v21
    v_xor_b32 v22, 192, v10
    v_add_u32 v22, s25, v22
    v_xor_b32 v23, 224, v10
    v_add_u32 v23, s25, v23
    v_bfe_u32 v10, v0, 2, 2
    v_lshl_add_u32 v11, v7, 3, v10
    v_lshlrev_b32 v11, 5, v11
    v_and_b32 v12, 3, v0
    v_lshl_add_u32 v11, v12, 3, v11
    v_bfe_u32 v12, v0, 4, 1
    s_movk_i32 s31, 16512
    v_mad_u32_u24 v32, v12, s31, v11
    s_add_u32 s25, s29, 32768
    v_add_u32 v32, s25, v32
    s_waitcnt vmcnt(0)
    s_barrier
    ds_read_b128 v[36:39], v16
    ds_read_b64_tr_b16 v[40:41], v32 offset:0
    ds_read_b64_tr_b16 v[42:43], v32 offset:128
    ds_read_b128 v[44:47], v17
    ds_read_b64_tr_b16 v[48:49], v32 offset:512
    ds_read_b64_tr_b16 v[50:51], v32 offset:640
    s_waitcnt lgkmcnt(3)
    v_mfma_f32_32x32x16_bf16 v[64:79], v[40:43], v[36:39], v[64:79]
    v_mfma_f32_32x32x16_bf16 v[80:95], v[40:43], v[96:99], v[80:95]
    v_lshlrev_b32 v108, 16, v36
    v_and_b32 v109, 0xffff0000, v36
    v_lshlrev_b32 v110, 16, v37
    v_and_b32 v111, 0xffff0000, v37
    v_lshlrev_b32 v112, 16, v38
    v_and_b32 v113, 0xffff0000, v38
    v_lshlrev_b32 v114, 16, v39
    v_and_b32 v115, 0xffff0000, v39
    v_pk_add_f32 v[100:101], v[100:101], v[108:109]
    v_pk_fma_f32 v[104:105], v[108:109], v[108:109], v[104:105]
    v_pk_add_f32 v[102:103], v[102:103], v[110:111]
    v_pk_fma_f32 v[106:107], v[110:111], v[110:111], v[106:107]
    v_pk_add_f32 v[100:101], v[100:101], v[112:113]
    v_pk_fma_f32 v[104:105], v[112:113], v[112:113], v[104:105]
    v_pk_add_f32 v[102:103], v[102:103], v[114:115]
    v_pk_fma_f32 v[106:107], v[114:115], v[114:115], v[106:107]
    ds_read_b128 v[36:39], v18
    ds_read_b64_tr_b16 v[40:41], v32 offset:1024
    ds_read_b64_tr_b16 v[42:43], v32 offset:1152
    s_waitcnt lgkmcnt(3)
    v_mfma_f32_32x32x16_bf16 v[64:79], v[48:51], v[44:47], v[64:79]
    v_mfma_f32_32x32x16_bf16 v[80:95], v[48:51], v[96:99], v[80:95]
    v_lshlrev_b32 v108, 16, v44
    v_and_b32 v109, 0xffff0000, v44
    v_lshlrev_b32 v110, 16, v45
    v_and_b32 v111, 0xffff0000, v45
    v_lshlrev_b32 v112, 16, v46
    v_and_b32 v113, 0xffff0000, v46
    v_lshlrev_b32 v114, 16, v47
    v_and_b32 v115, 0xffff0000, v47
    v_pk_add_f32 v[100:101], v[100:101], v[108:109]
    v_pk_fma_f32 v[104:105], v[108:109], v[108:109], v[104:105]
    v_pk_add_f32 v[102:103], v[102:103], v[110:111]
    v_pk_fma_f32 v[106:107], v[110:111], v[110:111], v[106:107]
    v_pk_add_f32 v[100:101], v[100:101], v[112:113]
    v_pk_fma_f32 v[104:105], v[112:113], v[112:113], v[104:105]
    v_pk_add_f32 v[102:103], v[102:103], v[114:115]
    v_pk_fma_f32 v[106:107], v[114:115], v[114:115], v[106:107]
    ds_read_b128 v[44:47], v19
    ds_read_b64_tr_b16 v[48:49], v32 offset:1536
    ds_read_b64_tr_b16 v[50:51], v32 offset:1664
    s_waitcnt lgkmcnt(3)
    v_mfma_f32_32x32x16_bf16 v[64:79], v[40:43], v[36:39], v[64:79]
    v_mfma_f32_32x32x16_bf16 v[80:95], v[40:43], v[96:99], v[80:95]
    v_lshlrev_b32 v108, 16, v36
    v_and_b32 v109, 0xffff0000, v36
    v_lshlrev_b32 v110, 16, v37
    v_and_b32 v111, 0xffff0000, v37
    v_lshlrev_b32 v112, 16, v38
    v_and_b32 v113, 0xffff0000, v38
    v_lshlrev_b32 v114, 16, v39
    v_and_b32 v115, 0xffff0000, v39
    v_pk_add_f32 v[100:101], v[100:101], v[108:109]
    v_pk_fma_f32 v[104:105], v[108:109], v[108:109], v[104:105]
    v_pk_add_f32 v[102:103], v[102:103], v[110:111]
    v_pk_fma_f32 v[106:107], v[110:111], v[110:111], v[106:107]
    v_pk_add_f32 v[100:101], v[100:101], v[112:113]
    v_pk_fma_f32 v[104:105], v[112:113], v[112:113], v[104:105]
    v_pk_add_f32 v[102:103], v[102:103], v[114:115]
    v_pk_fma_f32 v[106:107], v[114:115], v[114:115], v[106:107]
    ds_read_b128 v[36:39], v20
    ds_read_b64_tr_b16 v[40:41], v32 offset:2048
    ds_read_b64_tr_b16 v[42:43], v32 offset:2176
    s_waitcnt lgkmcnt(3)
    v_mfma_f32_32x32x16_bf16 v[64:79], v[48:51], v[44:47], v[64:79]
    v_mfma_f32_32x32x16_bf16 v[80:95], v[48:51], v[96:99], v[80:95]
    v_lshlrev_b32 v108, 16, v44
    v_and_b32 v109, 0xffff0000, v44
    v_lshlrev_b32 v110, 16, v45
    v_and_b32 v111, 0xffff0000, v45
    v_lshlrev_b32 v112, 16, v46
    v_and_b32 v113, 0xffff0000, v46
    v_lshlrev_b32 v114, 16, v47
    v_and_b32 v115, 0xffff0000, v47
    v_pk_add_f32 v[100:101], v[100:101], v[108:109]
    v_pk_fma_f32 v[104:105], v[108:109], v[108:109], v[104:105]
    v_pk_add_f32 v[102:103], v[102:103], v[110:111]
    v_pk_fma_f32 v[106:107], v[110:111], v[110:111], v[106:107]
    v_pk_add_f32 v[100:101], v[100:101], v[112:113]
    v_pk_fma_f32 v[104:105], v[112:113], v[112:113], v[104:105]
    v_pk_add_f32 v[102:103], v[102:103], v[114:115]
    v_pk_fma_f32 v[106:107], v[114:115], v[114:115], v[106:107]
    ds_read_b128 v[44:47], v21
    ds_read_b64_tr_b16 v[48:49], v32 offset:2560
    ds_read_b64_tr_b16 v[50:51], v32 offset:2688
    s_waitcnt lgkmcnt(3)
    v_mfma_f32_32x32x16_bf16 v[64:79], v[40:43], v[36:39], v[64:79]
    v_mfma_f32_32x32x16_bf16 v[80:95], v[40:43], v[96:99], v[80:95]
    v_lshlrev_b32 v108, 16, v36
    v_and_b32 v109, 0xffff0000, v36
    v_lshlrev_b32 v110, 16, v37
    v_and_b32 v111, 0xffff0000, v37
    v_lshlrev_b32 v112, 16, v38
    v_and_b32 v113, 0xffff0000, v38
    v_lshlrev_b32 v114, 16, v39
    v_and_b32 v115, 0xffff0000, v39
    v_pk_add_f32 v[100:101], v[100:101], v[108:109]
    v_pk_fma_f32 v[104:105], v[108:109], v[108:109], v[104:105]
    v_pk_add_f32 v[102:103], v[102:103], v[110:111]
    v_pk_fma_f32 v[106:107], v[110:111], v[110:111], v[106:107]
    v_pk_add_f32 v[100:101], v[100:101], v[112:113]
    v_pk_fma_f32 v[104:105], v[112:113], v[112:113], v[104:105]
    v_pk_add_f32 v[102:103], v[102:103], v[114:115]
    v_pk_fma_f32 v[106:107], v[114:115], v[114:115], v[106:107]
    ds_read_b128 v[36:39], v22
    ds_read_b64_tr_b16 v[40:41], v32 offset:3072
    ds_read_b64_tr_b16 v[42:43], v32 offset:3200
    s_waitcnt lgkmcnt(3)
    v_mfma_f32_32x32x16_bf16 v[64:79], v[48:51], v[44:47], v[64:79]
    v_mfma_f32_32x32x16_bf16 v[80:95], v[48:51], v[96:99], v[80:95]
    v_lshlrev_b32 v108, 16, v44
    v_and_b32 v109, 0xffff0000, v44
    v_lshlrev_b32 v110, 16, v45
    v_and_b32 v111, 0xffff0000, v45
    v_lshlrev_b32 v112, 16, v46
    v_and_b32 v113, 0xffff0000, v46
    v_lshlrev_b32 v114, 16, v47
    v_and_b32 v115, 0xffff0000, v47
    v_pk_add_f32 v[100:101], v[100:101], v[108:109]
    v_pk_fma_f32 v[104:105], v[108:109], v[108:109], v[104:105]
    v_pk_add_f32 v[102:103], v[102:103], v[110:111]
    v_pk_fma_f32 v[106:107], v[110:111], v[110:111], v[106:107]
    v_pk_add_f32 v[100:101], v[100:101], v[112:113]
    v_pk_fma_f32 v[104:105], v[112:113], v[112:113], v[104:105]
    v_pk_add_f32 v[102:103], v[102:103], v[114:115]
    v_pk_fma_f32 v[106:107], v[114:115], v[114:115], v[106:107]
    ds_read_b128 v[44:47], v23
    ds_read_b64_tr_b16 v[48:49], v32 offset:3584
    ds_read_b64_tr_b16 v[50:51], v32 offset:3712
    s_waitcnt lgkmcnt(3)
    v_mfma_f32_32x32x16_bf16 v[64:79], v[40:43], v[36:39], v[64:79]
    v_mfma_f32_32x32x16_bf16 v[80:95], v[40:43], v[96:99], v[80:95]
    v_lshlrev_b32 v108, 16, v36
    v_and_b32 v109, 0xffff0000, v36
    v_lshlrev_b32 v110, 16, v37
    v_and_b32 v111, 0xffff0000, v37
    v_lshlrev_b32 v112, 16, v38
    v_and_b32 v113, 0xffff0000, v38
    v_lshlrev_b32 v114, 16, v39
    v_and_b32 v115, 0xffff0000, v39
    v_pk_add_f32 v[100:101], v[100:101], v[108:109]
    v_pk_fma_f32 v[104:105], v[108:109], v[108:109], v[104:105]
    v_pk_add_f32 v[102:103], v[102:103], v[110:111]
    v_pk_fma_f32 v[106:107], v[110:111], v[110:111], v[106:107]
    v_pk_add_f32 v[100:101], v[100:101], v[112:113]
    v_pk_fma_f32 v[104:105], v[112:113], v[112:113], v[104:105]
    v_pk_add_f32 v[102:103], v[102:103], v[114:115]
    v_pk_fma_f32 v[106:107], v[114:115], v[114:115], v[106:107]
    s_waitcnt lgkmcnt(0)
    v_mfma_f32_32x32x16_bf16 v[64:79], v[48:51], v[44:47], v[64:79]
    v_mfma_f32_32x32x16_bf16 v[80:95], v[48:51], v[96:99], v[80:95]
    v_lshlrev_b32 v108, 16, v44
    v_and_b32 v109, 0xffff0000, v44
    v_lshlrev_b32 v110, 16, v45
    v_and_b32 v111, 0xffff0000, v45
    v_lshlrev_b32 v112, 16, v46
    v_and_b32 v113, 0xffff0000, v46
    v_lshlrev_b32 v114, 16, v47
    v_and_b32 v115, 0xffff0000, v47
    v_pk_add_f32 v[100:101], v[100:101], v[108:109]
    v_pk_fma_f32 v[104:105], v[108:109], v[108:109], v[104:105]
    v_pk_add_f32 v[102:103], v[102:103], v[110:111]
    v_pk_fma_f32 v[106:107], v[110:111], v[110:111], v[106:107]
    v_pk_add_f32 v[100:101], v[100:101], v[112:113]
    v_pk_fma_f32 v[104:105], v[112:113], v[112:113], v[104:105]
    v_pk_add_f32 v[102:103], v[102:103], v[114:115]
    v_pk_fma_f32 v[106:107], v[114:115], v[114:115], v[106:107]
    s_nop 15
    s_barrier
    s_mul_i32 s25, s20, 10240
    v_add_u32 v10, s25, v2
    s_cmp_eq_u32 s20, 0
    s_cbranch_scc1 L_qkv_kernel_kvr
    ds_write_b128 v10, v[64:67] offset:0
    ds_write_b128 v10, v[68:71] offset:1024
    ds_write_b128 v10, v[72:75] offset:2048
    ds_write_b128 v10, v[76:79] offset:3072
    ds_write_b128 v10, v[80:83] offset:4096
    ds_write_b128 v10, v[84:87] offset:5120
    ds_write_b128 v10, v[88:91] offset:6144
    ds_write_b128 v10, v[92:95] offset:7168
    ds_write_b128 v10, v[100:103] offset:8192
    ds_write_b128 v10, v[104:107] offset:9216
    s_waitcnt lgkmcnt(0)
    s_barrier
    s_branch L_qkv_kernel_end
L_qkv_kernel_kvr:
    s_barrier
    ds_read_b128 v[16:19], v10 offset:10240
    ds_read_b128 v[20:23], v10 offset:11264
    ds_read_b128 v[24:27], v10 offset:12288
    ds_read_b128 v[28:31], v10 offset:13312
    ds_read_b128 v[32:35], v10 offset:14336
    ds_read_b128 v[36:39], v10 offset:15360
    ds_read_b128 v[40:43], v10 offset:16384
    ds_read_b128 v[44:47], v10 offset:17408
    ds_read_b128 v[48:51], v10 offset:18432
    ds_read_b128 v[52:55], v10 offset:19456
    s_waitcnt lgkmcnt(0)
    v_add_f32 v64, v64, v16
    v_add_f32 v65, v65, v17
    v_add_f32 v66, v66, v18
    v_add_f32 v67, v67, v19
    v_add_f32 v68, v68, v20
    v_add_f32 v69, v69, v21
    v_add_f32 v70, v70, v22
    v_add_f32 v71, v71, v23
    v_add_f32 v72, v72, v24
    v_add_f32 v73, v73, v25
    v_add_f32 v74, v74, v26
    v_add_f32 v75, v75, v27
    v_add_f32 v76, v76, v28
    v_add_f32 v77, v77, v29
    v_add_f32 v78, v78, v30
    v_add_f32 v79, v79, v31
    v_add_f32 v80, v80, v32
    v_add_f32 v81, v81, v33
    v_add_f32 v82, v82, v34
    v_add_f32 v83, v83, v35
    v_add_f32 v84, v84, v36
    v_add_f32 v85, v85, v37
    v_add_f32 v86, v86, v38
    v_add_f32 v87, v87, v39
    v_add_f32 v88, v88, v40
    v_add_f32 v89, v89, v41
    v_add_f32 v90, v90, v42
    v_add_f32 v91, v91, v43
    v_add_f32 v92, v92, v44
    v_add_f32 v93, v93, v45
    v_add_f32 v94, v94, v46
    v_add_f32 v95, v95, v47
    v_add_f32 v100, v100, v48
    v_add_f32 v101, v101, v49
    v_add_f32 v102, v102, v50
    v_add_f32 v103, v103, v51
    v_add_f32 v104, v104, v52
    v_add_f32 v105, v105, v53
    v_add_f32 v106, v106, v54
    v_add_f32 v107, v107, v55
    ds_read_b128 v[16:19], v10 offset:20480
    ds_read_b128 v[20:23], v10 offset:21504
    ds_read_b128 v[24:27], v10 offset:22528
    ds_read_b128 v[28:31], v10 offset:23552
    ds_read_b128 v[32:35], v10 offset:24576
    ds_read_b128 v[36:39], v10 offset:25600
    ds_read_b128 v[40:43], v10 offset:26624
    ds_read_b128 v[44:47], v10 offset:27648
    ds_read_b128 v[48:51], v10 offset:28672
    ds_read_b128 v[52:55], v10 offset:29696
    s_waitcnt lgkmcnt(0)
    v_add_f32 v64, v64, v16
    v_add_f32 v65, v65, v17
    v_add_f32 v66, v66, v18
    v_add_f32 v67, v67, v19
    v_add_f32 v68, v68, v20
    v_add_f32 v69, v69, v21
    v_add_f32 v70, v70, v22
    v_add_f32 v71, v71, v23
    v_add_f32 v72, v72, v24
    v_add_f32 v73, v73, v25
    v_add_f32 v74, v74, v26
    v_add_f32 v75, v75, v27
    v_add_f32 v76, v76, v28
    v_add_f32 v77, v77, v29
    v_add_f32 v78, v78, v30
    v_add_f32 v79, v79, v31
    v_add_f32 v80, v80, v32
    v_add_f32 v81, v81, v33
    v_add_f32 v82, v82, v34
    v_add_f32 v83, v83, v35
    v_add_f32 v84, v84, v36
    v_add_f32 v85, v85, v37
    v_add_f32 v86, v86, v38
    v_add_f32 v87, v87, v39
    v_add_f32 v88, v88, v40
    v_add_f32 v89, v89, v41
    v_add_f32 v90, v90, v42
    v_add_f32 v91, v91, v43
    v_add_f32 v92, v92, v44
    v_add_f32 v93, v93, v45
    v_add_f32 v94, v94, v46
    v_add_f32 v95, v95, v47
    v_add_f32 v100, v100, v48
    v_add_f32 v101, v101, v49
    v_add_f32 v102, v102, v50
    v_add_f32 v103, v103, v51
    v_add_f32 v104, v104, v52
    v_add_f32 v105, v105, v53
    v_add_f32 v106, v106, v54
    v_add_f32 v107, v107, v55
    ds_read_b128 v[16:19], v10 offset:30720
    ds_read_b128 v[20:23], v10 offset:31744
    ds_read_b128 v[24:27], v10 offset:32768
    ds_read_b128 v[28:31], v10 offset:33792
    ds_read_b128 v[32:35], v10 offset:34816
    ds_read_b128 v[36:39], v10 offset:35840
    ds_read_b128 v[40:43], v10 offset:36864
    ds_read_b128 v[44:47], v10 offset:37888
    ds_read_b128 v[48:51], v10 offset:38912
    ds_read_b128 v[52:55], v10 offset:39936
    s_waitcnt lgkmcnt(0)
    v_add_f32 v64, v64, v16
    v_add_f32 v65, v65, v17
    v_add_f32 v66, v66, v18
    v_add_f32 v67, v67, v19
    v_add_f32 v68, v68, v20
    v_add_f32 v69, v69, v21
    v_add_f32 v70, v70, v22
    v_add_f32 v71, v71, v23
    v_add_f32 v72, v72, v24
    v_add_f32 v73, v73, v25
    v_add_f32 v74, v74, v26
    v_add_f32 v75, v75, v27
    v_add_f32 v76, v76, v28
    v_add_f32 v77, v77, v29
    v_add_f32 v78, v78, v30
    v_add_f32 v79, v79, v31
    v_add_f32 v80, v80, v32
    v_add_f32 v81, v81, v33
    v_add_f32 v82, v82, v34
    v_add_f32 v83, v83, v35
    v_add_f32 v84, v84, v36
    v_add_f32 v85, v85, v37
    v_add_f32 v86, v86, v38
    v_add_f32 v87, v87, v39
    v_add_f32 v88, v88, v40
    v_add_f32 v89, v89, v41
    v_add_f32 v90, v90, v42
    v_add_f32 v91, v91, v43
    v_add_f32 v92, v92, v44
    v_add_f32 v93, v93, v45
    v_add_f32 v94, v94, v46
    v_add_f32 v95, v95, v47
    v_add_f32 v100, v100, v48
    v_add_f32 v101, v101, v49
    v_add_f32 v102, v102, v50
    v_add_f32 v103, v103, v51
    v_add_f32 v104, v104, v52
    v_add_f32 v105, v105, v53
    v_add_f32 v106, v106, v54
    v_add_f32 v107, v107, v55
    v_add_f32 v100, v100, v101
    v_add_f32 v102, v102, v103
    v_add_f32 v104, v104, v105
    v_add_f32 v106, v106, v107
    v_add_f32 v100, v100, v102
    v_add_f32 v101, v104, v106
    v_mov_b32 v12, v100
    v_mov_b32 v13, v101
    s_nop 1
    v_permlane32_swap_b32 v100, v12
    v_permlane32_swap_b32 v101, v13
    s_nop 1
    v_add_f32 v100, v100, v12
    v_add_f32 v101, v101, v13
    v_mul_f32 v12, 0xbb000000, v100
    v_mul_f32 v13, 0x3b000000, v101
    v_fma_f32 v13, -v12, v12, v13
    v_max_f32 v13, 0, v13
    v_add_f32 v13, 0x3727c5ac, v13
    v_rsq_f32 v13, v13
    s_nop 0
    v_mul_f32 v13, 0x3f800000, v13
    v_fma_f32 v64, v12, v80, v64
    v_mul_f32 v64, v64, v13
    v_fma_f32 v65, v12, v81, v65
    v_mul_f32 v65, v65, v13
    v_fma_f32 v66, v12, v82, v66
    v_mul_f32 v66, v66, v13
    v_fma_f32 v67, v12, v83, v67
    v_mul_f32 v67, v67, v13
    v_fma_f32 v68, v12, v84, v68
    v_mul_f32 v68, v68, v13
    v_fma_f32 v69, v12, v85, v69
    v_mul_f32 v69, v69, v13
    v_fma_f32 v70, v12, v86, v70
    v_mul_f32 v70, v70, v13
    v_fma_f32 v71, v12, v87, v71
    v_mul_f32 v71, v71, v13
    v_fma_f32 v72, v12, v88, v72
    v_mul_f32 v72, v72, v13
    v_fma_f32 v73, v12, v89, v73
    v_mul_f32 v73, v73, v13
    v_fma_f32 v74, v12, v90, v74
    v_mul_f32 v74, v74, v13
    v_fma_f32 v75, v12, v91, v75
    v_mul_f32 v75, v75, v13
    v_fma_f32 v76, v12, v92, v76
    v_mul_f32 v76, v76, v13
    v_fma_f32 v77, v12, v93, v77
    v_mul_f32 v77, v77, v13
    v_fma_f32 v78, v12, v94, v78
    v_mul_f32 v78, v78, v13
    v_fma_f32 v79, v12, v95, v79
    v_mul_f32 v79, v79, v13
    v_cvt_pk_bf16_f32 v64, v64, v65
    v_cvt_pk_bf16_f32 v65, v66, v67
    v_cvt_pk_bf16_f32 v66, v68, v69
    v_cvt_pk_bf16_f32 v67, v70, v71
    v_cvt_pk_bf16_f32 v68, v72, v73
    v_cvt_pk_bf16_f32 v69, v74, v75
    v_cvt_pk_bf16_f32 v70, v76, v77
    v_cvt_pk_bf16_f32 v71, v78, v79
    v_lshlrev_b32 v10, 3, v5
    s_lshl_b32 s38, s21, 3
    s_add_u32 s38, s38, 2260992
    buffer_store_dwordx2 v[12:13], v10, s[16:19], s38 offen
    s_mov_b32 s25, s21
    v_lshlrev_b32 v10, 4, v5
    v_lshl_add_u32 v10, v7, 3, v10
    s_lshl_b32 s38, s25, 5
    s_add_u32 s39, s38, 2097152
    buffer_store_dwordx2 v[64:65], v10, s[16:19], s39 offen
    buffer_store_dwordx2 v[66:67], v10, s[16:19], s39 offen offset:512
    v_mov_b32 v100, 0
    v_dot2_f32_bf16 v100, v64, v64, v100
    v_dot2_f32_bf16 v100, v65, v65, v100
    v_dot2_f32_bf16 v100, v66, v66, v100
    v_dot2_f32_bf16 v100, v67, v67, v100
    v_and_b32 v11, 19, v5
    v_bfe_u32 v12, v5, 2, 1
    v_lshl_add_u32 v11, v12, 3, v11
    v_bfe_u32 v12, v5, 3, 1
    v_lshl_add_u32 v11, v12, 2, v11
    v_lshlrev_b32 v11, 1, v11
    v_lshl_add_u32 v11, v7, 14, v11
    s_lshl_b32 s38, s25, 1
    s_add_u32 s39, s38, 2162688
    v_mov_b32 v31, v100
    s_add_u32 s38, s39, 0
    buffer_store_short v68, v11, s[16:19], s38 offen
    s_add_u32 s38, s39, 4096
    buffer_store_short_d16_hi v68, v11, s[16:19], s38 offen
    s_add_u32 s38, s39, 8192
    buffer_store_short v69, v11, s[16:19], s38 offen
    s_add_u32 s38, s39, 12288
    buffer_store_short_d16_hi v69, v11, s[16:19], s38 offen
    s_add_u32 s38, s39, 32768
    buffer_store_short v70, v11, s[16:19], s38 offen
    s_add_u32 s38, s39, 36864
    buffer_store_short_d16_hi v70, v11, s[16:19], s38 offen
    s_add_u32 s38, s39, 40960
    buffer_store_short v71, v11, s[16:19], s38 offen
    s_add_u32 s38, s39, 45056
    buffer_store_short_d16_hi v71, v11, s[16:19], s38 offen
    v_permlane32_swap_b32 v100, v31
    s_nop 1
    v_add_f32 v100, v100, v31
    s_nop 1
    v_max_f32_dpp v100, v100, v100 quad_perm:[1,0,3,2] row_mask:0xf bank_mask:0xf
    s_nop 1
    v_max_f32_dpp v100, v100, v100 quad_perm:[2,3,0,1] row_mask:0xf bank_mask:0xf
    s_nop 1
    v_max_f32_dpp v100, v100, v100 row_ror:4 row_mask:0xf bank_mask:0xf
    s_nop 1
    v_max_f32_dpp v100, v100, v100 row_ror:8 row_mask:0xf bank_mask:0xf
    s_nop 1
    v_mov_b32 v31, v100
    s_nop 1
    v_permlane16_swap_b32 v100, v31
    s_nop 1
    v_max_f32 v100, v100, v31
    s_lshr_b32 s38, s25, 3
    s_add_u32 s38, s38, 2228224
    v_mov_b32 v10, 0
    buffer_store_dword v100, v10, s[16:19], s38 offen
    s_cmp_lg_u32 s25, 0
    s_cbranch_scc1 L_qkv_kernel_end
    v_mov_b32 v16, 0
    v_mov_b32 v17, 0
    v_mov_b32 v18, 0
    v_mov_b32 v19, 0
    s_mov_b32 s38, 2232320
    buffer_store_dwordx4 v[16:19], v2, s[16:19], s38 offen
    s_add_u32 s38, s38, 1024
    buffer_store_dwordx4 v[16:19], v2, s[16:19], s38 offen
    s_add_u32 s38, s38, 1024
    buffer_store_dwordx4 v[16:19], v2, s[16:19], s38 offen
    s_add_u32 s38, s38, 1024
    buffer_store_dwordx4 v[16:19], v2, s[16:19], s38 offen
    s_add_u32 s38, s38, 1024
    buffer_store_dwordx4 v[16:19], v2, s[16:19], s38 offen
    s_add_u32 s38, s38, 1024
    buffer_store_dwordx4 v[16:19], v2, s[16:19], s38 offen
    s_add_u32 s38, s38, 1024
    buffer_store_dwordx4 v[16:19], v2, s[16:19], s38 offen
    s_add_u32 s38, s38, 1024
    buffer_store_dwordx4 v[16:19], v2, s[16:19], s38 offen
    s_add_u32 s38, s38, 1024
    buffer_store_dwordx4 v[16:19], v2, s[16:19], s38 offen
    s_add_u32 s38, s38, 1024
    buffer_store_dwordx4 v[16:19], v2, s[16:19], s38 offen
    s_add_u32 s38, s38, 1024
    buffer_store_dwordx4 v[16:19], v2, s[16:19], s38 offen
    s_add_u32 s38, s38, 1024
    buffer_store_dwordx4 v[16:19], v2, s[16:19], s38 offen
    s_add_u32 s38, s38, 1024
    buffer_store_dwordx4 v[16:19], v2, s[16:19], s38 offen
    s_add_u32 s38, s38, 1024
    buffer_store_dwordx4 v[16:19], v2, s[16:19], s38 offen
    s_add_u32 s38, s38, 1024
L_qkv_kernel_end:
    s_endpgm
.globl attn_kernel
.p2align 8
.type attn_kernel,@function
attn_kernel:
    s_cmp_ge_u32 s2, 256
    s_cbranch_scc1 L_attn_end
    s_load_dwordx2 s[4:5], s[0:1], 88
    s_load_dwordx4 s[32:35], s[0:1], 48
    s_load_dwordx2 s[60:61], s[0:1], 32
    s_load_dwordx2 s[62:63], s[0:1], 64
    v_and_b32 v4, 63, v0
    v_lshrrev_b32 v5, 6, v0
    v_lshlrev_b32 v1, 4, v4
    v_readfirstlane_b32 s20, v5
    v_and_b32 v6, 31, v0
    v_lshlrev_b32 v6, 5, v6
    v_bfe_u32 v7, v0, 5, 1
    v_lshl_or_b32 v6, v7, 4, v6
    v_lshlrev_b32 v57, 2, v4
    s_waitcnt lgkmcnt(0)
    s_mov_b32 s8, s4
    s_mov_b32 s9, s5
    s_mov_b32 s10, 268435456
    s_mov_b32 s11, 0x00020000
    s_and_b32 s21, s20, 3
    s_lshr_b32 s22, s20, 2
    s_lshl_b32 s24, s2, 13
    s_lshl_b32 s23, s21, 11
    s_add_u32 s24, s24, s23
    s_mov_b32 s53, 0
    s_mov_b32 s52, 0
    s_mul_i32 s26, s21, 4608
    s_add_u32 s26, s26, 139552
    v_add_u32 v59, s26, v1
    s_lshl_b32 s25, s21, 12
    s_mul_i32 s28, s21, 16448
    s_lshl_b32 s29, s21, 14
    s_cmp_eq_u32 s22, 0
    s_cbranch_scc1 L_attn_roleD
    s_mov_b32 s25, 2228224
    s_lshl_b32 s26, s24, 1
    s_add_u32 s26, s26, 20971520
    s_mov_b32 s27, 2252800
    v_lshlrev_b32 v58, 1, v6
    s_lshr_b32 s28, s24, 7
    s_add_u32 s28, s28, 2260992
    s_add_u32 s4, s4, s28
    s_addc_u32 s5, s5, 0
    s_load_dwordx4 s[64:67], s[4:5], 0
    buffer_load_dwordx4 v[96:99], v58, s[8:11], s26 offen
    buffer_load_dwordx4 v[100:103], v58, s[8:11], s26 offen offset:16
    buffer_load_dwordx4 v[104:107], v58, s[8:11], s26 offen offset:2048
    buffer_load_dwordx4 v[108:111], v58, s[8:11], s26 offen offset:2064
    buffer_load_dwordx4 v[112:115], v58, s[8:11], s27 offen
    buffer_load_dwordx4 v[116:119], v58, s[8:11], s27 offen offset:16
    buffer_load_dword v56, v57, s[8:11], s25 offen
    v_and_b32 v5, 255, v0
    v_lshlrev_b32 v5, 4, v5
    v_mov_b32 v60, 0x3f803f80
    v_mov_b32 v61, 0x3f803f80
    v_mov_b32 v62, 0x3f803f80
    v_mov_b32 v63, 0x3f803f80
    v_add_u32 v5, 131328, v5
    ds_write_b128 v5, v[60:63]
    v_mov_b32 v40, 0
    v_mov_b32 v41, 0
    v_mov_b32 v42, 0
    v_mov_b32 v43, 0
    ds_write_b128 v5, v[40:43] offset:4112
    v_mov_b32 v5, 157984
    ds_write_b32 v5, v40
    s_waitcnt vmcnt(0) lgkmcnt(0)
    v_mov_b32 v58, 0x3eb8aa3b
    v_mul_f32 v60, s67, v58
    v_mul_f32 v58, s65, v58
    v_fma_f32 v96, s64, v112, v96
    v_fma_f32 v104, s66, v112, v104
    v_fma_f32 v97, s64, v113, v97
    v_fma_f32 v105, s66, v113, v105
    v_fma_f32 v98, s64, v114, v98
    v_fma_f32 v106, s66, v114, v106
    v_fma_f32 v99, s64, v115, v99
    v_fma_f32 v107, s66, v115, v107
    v_fma_f32 v100, s64, v116, v100
    v_fma_f32 v108, s66, v116, v108
    v_fma_f32 v101, s64, v117, v101
    v_fma_f32 v109, s66, v117, v109
    v_fma_f32 v102, s64, v118, v102
    v_fma_f32 v110, s66, v118, v110
    v_fma_f32 v103, s64, v119, v103
    v_fma_f32 v111, s66, v119, v111
    v_mul_f32 v96, v96, v58
    v_mul_f32 v104, v104, v60
    v_mul_f32 v97, v97, v58
    v_mul_f32 v105, v105, v60
    v_mul_f32 v98, v98, v58
    v_mul_f32 v106, v106, v60
    v_mul_f32 v99, v99, v58
    v_mul_f32 v107, v107, v60
    v_mul_f32 v100, v100, v58
    v_mul_f32 v108, v108, v60
    v_mul_f32 v101, v101, v58
    v_mul_f32 v109, v109, v60
    v_mul_f32 v102, v102, v58
    v_mul_f32 v110, v110, v60
    v_mul_f32 v103, v103, v58
    v_mul_f32 v111, v111, v60
    v_cvt_pk_bf16_f32 v8, v96, v97
    v_cvt_pk_bf16_f32 v12, v104, v105
    v_cvt_pk_bf16_f32 v9, v98, v99
    v_cvt_pk_bf16_f32 v13, v106, v107
    v_cvt_pk_bf16_f32 v10, v100, v101
    v_cvt_pk_bf16_f32 v14, v108, v109
    v_cvt_pk_bf16_f32 v11, v102, v103
    v_cvt_pk_bf16_f32 v15, v110, v111
    v_max_f32_dpp v56, v56, v56 quad_perm:[1,0,3,2] row_mask:0xf bank_mask:0xf
    v_mov_b32 v4, 0
    v_mov_b32 v5, 0
    v_max_f32_dpp v56, v56, v56 quad_perm:[2,3,0,1] row_mask:0xf bank_mask:0xf
    ds_write_b128 v59, v[8:11]
    ds_write_b128 v59, v[12:15] offset:1024
    v_dot2_f32_bf16 v4, v8, v8, v4
    v_dot2_f32_bf16 v5, v12, v12, v5
    v_max_f32_dpp v56, v56, v56 row_ror:4 row_mask:0xf bank_mask:0xf
    v_dot2_f32_bf16 v4, v9, v9, v4
    v_dot2_f32_bf16 v5, v13, v13, v5
    v_max_f32_dpp v56, v56, v56 row_ror:8 row_mask:0xf bank_mask:0xf
    v_dot2_f32_bf16 v4, v10, v10, v4
    v_dot2_f32_bf16 v5, v14, v14, v5
    v_mov_b32 v57, v56
    v_dot2_f32_bf16 v4, v11, v11, v4
    v_dot2_f32_bf16 v5, v15, v15, v5
    s_nop 1
    v_permlane16_swap_b32 v56, v57
    s_nop 1
    v_max_f32 v56, v56, v57
    v_mov_b32 v58, v4
    v_mov_b32 v57, v56
    v_mov_b32 v60, v5
    s_nop 1
    v_permlane32_swap_b32 v56, v57
    v_permlane32_swap_b32 v4, v58
    v_permlane32_swap_b32 v5, v60
    s_nop 1
    v_max_f32 v56, v56, v57
    v_add_f32 v4, v4, v58
    v_add_f32 v5, v5, v60
    v_mul_f32 v4, v4, v56
    v_mul_f32 v5, v5, v56
    v_sqrt_f32 v4, v4
    v_sqrt_f32 v5, v5
    s_nop 0
    ds_write_b64 v59, v[4:5] offset:2048
    s_waitcnt lgkmcnt(0)
    s_barrier
    s_branch L_attn_pass
L_attn_roleD:
    s_add_u32 s26, s25, 0
    s_mov_b32 m0, s26
    s_add_u32 s27, s26, 2097152
    buffer_load_dwordx4 v1, s[8:11], s27 offen lds
    s_add_u32 s26, s25, 1024
    s_mov_b32 m0, s26
    s_add_u32 s27, s26, 2097152
    buffer_load_dwordx4 v1, s[8:11], s27 offen lds
    s_add_u32 s26, s25, 2048
    s_mov_b32 m0, s26
    s_add_u32 s27, s26, 2097152
    buffer_load_dwordx4 v1, s[8:11], s27 offen lds
    s_add_u32 s26, s25, 3072
    s_mov_b32 m0, s26
    s_add_u32 s27, s26, 2097152
    buffer_load_dwordx4 v1, s[8:11], s27 offen lds
    s_add_u32 s26, s25, 32768
    s_mov_b32 m0, s26
    s_add_u32 s27, s26, 2097152
    buffer_load_dwordx4 v1, s[8:11], s27 offen lds
    s_add_u32 s26, s25, 33792
    s_mov_b32 m0, s26
    s_add_u32 s27, s26, 2097152
    buffer_load_dwordx4 v1, s[8:11], s27 offen lds
    s_add_u32 s26, s25, 34816
    s_mov_b32 m0, s26
    s_add_u32 s27, s26, 2097152
    buffer_load_dwordx4 v1, s[8:11], s27 offen lds
    s_add_u32 s26, s25, 35840
    s_mov_b32 m0, s26
    s_add_u32 s27, s26, 2097152
    buffer_load_dwordx4 v1, s[8:11], s27 offen lds
    s_add_u32 s26, s28, 65536
    s_mov_b32 m0, s26
    s_add_u32 s27, s29, 2162688
    buffer_load_dwordx4 v1, s[8:11], s27 offen lds
    s_add_u32 s26, s28, 67584
    s_mov_b32 m0, s26
    s_add_u32 s27, s29, 2164736
    buffer_load_dwordx4 v1, s[8:11], s27 offen lds
    s_add_u32 s26, s28, 69648
    s_mov_b32 m0, s26
    s_add_u32 s27, s29, 2166784
    buffer_load_dwordx4 v1, s[8:11], s27 offen lds
    s_add_u32 s26, s28, 71696
    s_mov_b32 m0, s26
    s_add_u32 s27, s29, 2168832
    buffer_load_dwordx4 v1, s[8:11], s27 offen lds
    s_add_u32 s26, s28, 73760
    s_mov_b32 m0, s26
    s_add_u32 s27, s29, 2170880
    buffer_load_dwordx4 v1, s[8:11], s27 offen lds
    s_add_u32 s26, s28, 75808
    s_mov_b32 m0, s26
    s_add_u32 s27, s29, 2172928
    buffer_load_dwordx4 v1, s[8:11], s27 offen lds
    s_add_u32 s26, s28, 77872
    s_mov_b32 m0, s26
    s_add_u32 s27, s29, 2174976
    buffer_load_dwordx4 v1, s[8:11], s27 offen lds
    s_add_u32 s26, s28, 79920
    s_mov_b32 m0, s26
    s_add_u32 s27, s29, 2177024
    buffer_load_dwordx4 v1, s[8:11], s27 offen lds
    s_waitcnt vmcnt(0)
    s_barrier
    ds_read_b128 v[8:11], v59
    ds_read_b128 v[12:15], v59 offset:1024
    ds_read_b64 v[4:5], v59 offset:2048
    s_add_u32 s26, s25, 16384
    s_mov_b32 m0, s26
    s_add_u32 s27, s26, 2097152
    buffer_load_dwordx4 v1, s[8:11], s27 offen lds
    s_add_u32 s26, s25, 17408
    s_mov_b32 m0, s26
    s_add_u32 s27, s26, 2097152
    buffer_load_dwordx4 v1, s[8:11], s27 offen lds
    s_add_u32 s26, s25, 18432
    s_mov_b32 m0, s26
    s_add_u32 s27, s26, 2097152
    buffer_load_dwordx4 v1, s[8:11], s27 offen lds
    s_add_u32 s26, s25, 19456
    s_mov_b32 m0, s26
    s_add_u32 s27, s26, 2097152
    buffer_load_dwordx4 v1, s[8:11], s27 offen lds
    s_add_u32 s26, s25, 49152
    s_mov_b32 m0, s26
    s_add_u32 s27, s26, 2097152
    buffer_load_dwordx4 v1, s[8:11], s27 offen lds
    s_add_u32 s26, s25, 50176
    s_mov_b32 m0, s26
    s_add_u32 s27, s26, 2097152
    buffer_load_dwordx4 v1, s[8:11], s27 offen lds
    s_add_u32 s26, s25, 51200
    s_mov_b32 m0, s26
    s_add_u32 s27, s26, 2097152
    buffer_load_dwordx4 v1, s[8:11], s27 offen lds
    s_add_u32 s26, s25, 52224
    s_mov_b32 m0, s26
    s_add_u32 s27, s26, 2097152
    buffer_load_dwordx4 v1, s[8:11], s27 offen lds
    s_add_u32 s26, s28, 66560
    s_mov_b32 m0, s26
    s_add_u32 s27, s29, 2163712
    buffer_load_dwordx4 v1, s[8:11], s27 offen lds
    s_add_u32 s26, s28, 68608
    s_mov_b32 m0, s26
    s_add_u32 s27, s29, 2165760
    buffer_load_dwordx4 v1, s[8:11], s27 offen lds
    s_add_u32 s26, s28, 70672
    s_mov_b32 m0, s26
    s_add_u32 s27, s29, 2167808
    buffer_load_dwordx4 v1, s[8:11], s27 offen lds
    s_add_u32 s26, s28, 72720
    s_mov_b32 m0, s26
    s_add_u32 s27, s29, 2169856
    buffer_load_dwordx4 v1, s[8:11], s27 offen lds
    s_add_u32 s26, s28, 74784
    s_mov_b32 m0, s26
    s_add_u32 s27, s29, 2171904
    buffer_load_dwordx4 v1, s[8:11], s27 offen lds
    s_add_u32 s26, s28, 76832
    s_mov_b32 m0, s26
    s_add_u32 s27, s29, 2173952
    buffer_load_dwordx4 v1, s[8:11], s27 offen lds
    s_add_u32 s26, s28, 78896
    s_mov_b32 m0, s26
    s_add_u32 s27, s29, 2176000
    buffer_load_dwordx4 v1, s[8:11], s27 offen lds
    s_add_u32 s26, s28, 80944
    s_mov_b32 m0, s26
    s_add_u32 s27, s29, 2178048
    buffer_load_dwordx4 v1, s[8:11], s27 offen lds
    s_waitcnt lgkmcnt(0)
    s_mov_b32 s40, s60
    s_mov_b32 s41, s61
    s_mov_b32 s42, 524288
    s_mov_b32 s43, 0x00020000
    s_mov_b32 s44, s62
    s_mov_b32 s45, s63
    s_mov_b32 s46, 1835008
    s_mov_b32 s47, 0x00020000
    s_lshl_b32 s38, s2, 2
    s_add_u32 s38, s38, s21
    s_lshl_b32 s39, s38, 9
    s_mul_i32 s50, s38, 1792
    buffer_load_dwordx4 v[176:179], v1, s[40:43], s39 offen
    buffer_load_dwordx4 v[176:179], v1, s[44:47], s50 offen
    buffer_load_dwordx4 v[176:179], v1, s[44:47], s50 offen offset:1024
    s_mov_b32 s40, s32
    s_mov_b32 s41, s33
    s_mov_b32 s42, 1835008
    s_mov_b32 s43, 0x00020000
    s_mov_b32 s44, s34
    s_mov_b32 s45, s35
    s_mov_b32 s46, 1835008
    s_mov_b32 s47, 0x00020000
    s_cmp_ge_u32 s38, 896
    s_cbranch_scc1 L_attn_pass
    s_mov_b32 s52, 1
    s_cmp_ge_u32 s38, 448
    s_cselect_b32 s39, 448, 0
    s_cselect_b32 s48, 1792, 0
    s_cselect_b32 s40, s44, s40
    s_cselect_b32 s41, s45, s41
    s_sub_u32 s38, s38, s39
    s_mul_i32 s39, s38, 9363
    s_lshr_b32 s39, s39, 16
    s_mul_i32 s49, s39, 7
    s_sub_u32 s49, s38, s49
    s_mul_i32 s50, s39, 28672
    s_lshl_b32 s51, s49, 9
    s_add_u32 s50, s50, s51
    v_lshrrev_b32 v58, 1, v1
    buffer_load_dwordx2 v[160:161], v58, s[40:43], s50 offen
    s_add_u32 s50, s50, 3584
    buffer_load_dwordx2 v[162:163], v58, s[40:43], s50 offen
    s_add_u32 s50, s50, 3584
    buffer_load_dwordx2 v[164:165], v58, s[40:43], s50 offen
    s_add_u32 s50, s50, 3584
    buffer_load_dwordx2 v[166:167], v58, s[40:43], s50 offen
    s_add_u32 s50, s50, 3584
    buffer_load_dwordx2 v[168:169], v58, s[40:43], s50 offen
    s_add_u32 s50, s50, 3584
    buffer_load_dwordx2 v[170:171], v58, s[40:43], s50 offen
    s_add_u32 s50, s50, 3584
    buffer_load_dwordx2 v[172:173], v58, s[40:43], s50 offen
    s_add_u32 s50, s50, 3584
    buffer_load_dwordx2 v[174:175], v58, s[40:43], s50 offen
L_attn_pass:
    s_cmp_eq_u32 s22, 0
    s_cbranch_scc1 L_attn_np
    s_setprio 1
L_attn_np:
    s_lshl_b32 s26, s22, 15
    v_add_u32 v2, s26, v1
    v_and_b32 v58, 31, v0
    v_min_u32 v58, 17, v58
    s_movk_i32 s27, 4112
    v_mul_lo_u32 v58, v58, s27
    v_lshl_add_u32 v58, v7, 4, v58
    s_lshl_b32 s26, s22, 11
    s_add_u32 s26, s26, 65536
    v_add_u32 v3, s26, v58
    ds_read_b128 v[16:19], v2
    ds_read_b128 v[20:23], v2 offset:1024
    ds_read_b128 v[24:27], v3
    ds_read_b128 v[28:31], v3 offset:32
    v_sub_f32 v64, 0, v4
    v_sub_f32 v80, 0, v5
    v_sub_f32 v65, 0, v4
    v_sub_f32 v81, 0, v5
    v_sub_f32 v66, 0, v4
    v_sub_f32 v82, 0, v5
    v_sub_f32 v67, 0, v4
    v_sub_f32 v83, 0, v5
    v_sub_f32 v68, 0, v4
    v_sub_f32 v84, 0, v5
    v_sub_f32 v69, 0, v4
    v_sub_f32 v85, 0, v5
    v_sub_f32 v70, 0, v4
    v_sub_f32 v86, 0, v5
    v_sub_f32 v71, 0, v4
    v_sub_f32 v87, 0, v5
    v_sub_f32 v72, 0, v4
    v_sub_f32 v88, 0, v5
    v_sub_f32 v73, 0, v4
    v_sub_f32 v89, 0, v5
    v_sub_f32 v74, 0, v4
    v_sub_f32 v90, 0, v5
    v_sub_f32 v75, 0, v4
    v_sub_f32 v91, 0, v5
    v_sub_f32 v76, 0, v4
    v_sub_f32 v92, 0, v5
    v_sub_f32 v77, 0, v4
    v_sub_f32 v93, 0, v5
    v_sub_f32 v78, 0, v4
    v_sub_f32 v94, 0, v5
    v_sub_f32 v79, 0, v4
    v_sub_f32 v95, 0, v5
    v_mov_b32 v128, 0
    v_mov_b32 v144, 0
    v_mov_b32 v129, 0
    v_mov_b32 v145, 0
    v_mov_b32 v130, 0
    v_mov_b32 v146, 0
    v_mov_b32 v131, 0
    v_mov_b32 v147, 0
    v_mov_b32 v132, 0
    v_mov_b32 v148, 0
    v_mov_b32 v133, 0
    v_mov_b32 v149, 0
    v_mov_b32 v134, 0
    v_mov_b32 v150, 0
    v_mov_b32 v135, 0
    v_mov_b32 v151, 0
    v_mov_b32 v136, 0
    v_mov_b32 v152, 0
    v_mov_b32 v137, 0
    v_mov_b32 v153, 0
    v_mov_b32 v138, 0
    v_mov_b32 v154, 0
    v_mov_b32 v139, 0
    v_mov_b32 v155, 0
    v_mov_b32 v140, 0
    v_mov_b32 v156, 0
    v_mov_b32 v141, 0
    v_mov_b32 v157, 0
    v_mov_b32 v142, 0
    v_mov_b32 v158, 0
    v_mov_b32 v143, 0
    v_mov_b32 v159, 0
    v_mov_b32 v52, 0
    v_mov_b32 v36, 0
    v_mov_b32 v53, 0
    v_mov_b32 v37, 0
    v_mov_b32 v54, 0
    v_mov_b32 v38, 0
    v_mov_b32 v55, 0
    v_mov_b32 v39, 0
    s_waitcnt lgkmcnt(3)
    v_mfma_f32_32x32x16_bf16 v[96:111], v[16:19], v[8:11], v[64:79]
    s_mov_b32 s30, 16
    s_nop 9
L_attn_loop:
    s_cmp_lg_u32 s30, 9
    s_cbranch_scc1 L_attn_nb
    s_waitcnt vmcnt(0)
    s_barrier
    s_cmp_lg_u32 s52, 1
    s_cbranch_scc1 L_attn_nb
    s_mov_b32 s52, 0
    v_mov_b32 v58, 0x00003f80
    v_mov_b32 v59, 0x3f800000
    v_mov_b32 v60, 0
    v_mov_b32 v61, 0
    v_mov_b32 v62, 0
    v_mov_b32 v63, 0
    v_dot2_f32_bf16 v60, v160, v58, v60
    v_dot2_f32_bf16 v61, v160, v59, v61
    v_dot2_f32_bf16 v62, v161, v58, v62
    v_dot2_f32_bf16 v63, v161, v59, v63
    v_dot2_f32_bf16 v60, v162, v58, v60
    v_dot2_f32_bf16 v61, v162, v59, v61
    v_dot2_f32_bf16 v62, v163, v58, v62
    v_dot2_f32_bf16 v63, v163, v59, v63
    v_dot2_f32_bf16 v60, v164, v58, v60
    v_dot2_f32_bf16 v61, v164, v59, v61
    v_dot2_f32_bf16 v62, v165, v58, v62
    v_dot2_f32_bf16 v63, v165, v59, v63
    v_dot2_f32_bf16 v60, v166, v58, v60
    v_dot2_f32_bf16 v61, v166, v59, v61
    v_dot2_f32_bf16 v62, v167, v58, v62
    v_dot2_f32_bf16 v63, v167, v59, v63
    v_dot2_f32_bf16 v60, v168, v58, v60
    v_dot2_f32_bf16 v61, v168, v59, v61
    v_dot2_f32_bf16 v62, v169, v58, v62
    v_dot2_f32_bf16 v63, v169, v59, v63
    v_dot2_f32_bf16 v60, v170, v58, v60
    v_dot2_f32_bf16 v61, v170, v59, v61
    v_dot2_f32_bf16 v62, v171, v58, v62
    v_dot2_f32_bf16 v63, v171, v59, v63
    v_dot2_f32_bf16 v60, v172, v58, v60
    v_dot2_f32_bf16 v61, v172, v59, v61
    v_dot2_f32_bf16 v62, v173, v58, v62
    v_dot2_f32_bf16 v63, v173, v59, v63
    v_dot2_f32_bf16 v60, v174, v58, v60
    v_dot2_f32_bf16 v61, v174, v59, v61
    v_dot2_f32_bf16 v62, v175, v58, v62
    v_dot2_f32_bf16 v63, v175, v59, v63
    s_lshl_b32 s51, s49, 8
    s_add_u32 s51, s51, s48
    s_lshl_b32 s51, s51, 2
    s_add_u32 s51, s51, 2232320
    s_nop 2
    buffer_atomic_add_f32 v60, v1, s[8:11], s51 offen
    buffer_atomic_add_f32 v61, v1, s[8:11], s51 offen offset:4
    buffer_atomic_add_f32 v62, v1, s[8:11], s51 offen offset:8
    buffer_atomic_add_f32 v63, v1, s[8:11], s51 offen offset:12
L_attn_nb:
    s_waitcnt lgkmcnt(0)
    v_exp_f32 v96, v96
    v_exp_f32 v97, v97
    v_exp_f32 v98, v98
    v_exp_f32 v99, v99
    v_mfma_f32_32x32x16_bf16 v[144:159], v[36:39], v[52:55], v[144:159]
    ds_read_b128 v[32:35], v3 offset:64
    ds_read_b128 v[36:39], v3 offset:96
    v_exp_f32 v100, v100
    v_exp_f32 v101, v101
    v_exp_f32 v102, v102
    v_exp_f32 v103, v103
    v_cvt_pk_bf16_f32 v40, v96, v97
    v_cvt_pk_bf16_f32 v41, v98, v99
    v_cvt_pk_bf16_f32 v42, v100, v101
    v_cvt_pk_bf16_f32 v43, v102, v103
    v_mfma_f32_32x32x16_bf16 v[112:127], v[16:19], v[12:15], v[80:95]
    ds_read_b128 v[16:19], v2 offset:2048
    v_exp_f32 v104, v104
    v_exp_f32 v105, v105
    v_exp_f32 v106, v106
    v_exp_f32 v107, v107
    v_mfma_f32_32x32x16_bf16 v[128:143], v[24:27], v[40:43], v[128:143]
    v_exp_f32 v108, v108
    v_exp_f32 v109, v109
    v_exp_f32 v110, v110
    v_exp_f32 v111, v111
    v_cvt_pk_bf16_f32 v44, v104, v105
    v_cvt_pk_bf16_f32 v45, v106, v107
    v_cvt_pk_bf16_f32 v46, v108, v109
    v_cvt_pk_bf16_f32 v47, v110, v111
    v_exp_f32 v112, v112
    v_exp_f32 v113, v113
    v_exp_f32 v114, v114
    v_exp_f32 v115, v115
    v_mfma_f32_32x32x16_bf16 v[128:143], v[28:31], v[44:47], v[128:143]
    v_exp_f32 v116, v116
    v_exp_f32 v117, v117
    v_exp_f32 v118, v118
    v_exp_f32 v119, v119
    v_cvt_pk_bf16_f32 v48, v112, v113
    v_cvt_pk_bf16_f32 v49, v114, v115
    v_cvt_pk_bf16_f32 v50, v116, v117
    v_cvt_pk_bf16_f32 v51, v118, v119
    v_mfma_f32_32x32x16_bf16 v[96:111], v[20:23], v[8:11], v[64:79]
    v_exp_f32 v120, v120
    v_exp_f32 v121, v121
    v_exp_f32 v122, v122
    v_exp_f32 v123, v123
    v_mfma_f32_32x32x16_bf16 v[144:159], v[24:27], v[48:51], v[144:159]
    v_exp_f32 v124, v124
    v_exp_f32 v125, v125
    v_exp_f32 v126, v126
    v_exp_f32 v127, v127
    v_cvt_pk_bf16_f32 v52, v120, v121
    v_cvt_pk_bf16_f32 v53, v122, v123
    v_cvt_pk_bf16_f32 v54, v124, v125
    v_cvt_pk_bf16_f32 v55, v126, v127
    s_waitcnt lgkmcnt(0)
    v_exp_f32 v96, v96
    v_exp_f32 v97, v97
    v_exp_f32 v98, v98
    v_exp_f32 v99, v99
    v_mfma_f32_32x32x16_bf16 v[144:159], v[28:31], v[52:55], v[144:159]
    ds_read_b128 v[24:27], v3 offset:128
    ds_read_b128 v[28:31], v3 offset:160
    v_exp_f32 v100, v100
    v_exp_f32 v101, v101
    v_exp_f32 v102, v102
    v_exp_f32 v103, v103
    v_cvt_pk_bf16_f32 v40, v96, v97
    v_cvt_pk_bf16_f32 v41, v98, v99
    v_cvt_pk_bf16_f32 v42, v100, v101
    v_cvt_pk_bf16_f32 v43, v102, v103
    v_mfma_f32_32x32x16_bf16 v[112:127], v[20:23], v[12:15], v[80:95]
    ds_read_b128 v[20:23], v2 offset:3072
    v_exp_f32 v104, v104
    v_exp_f32 v105, v105
    v_exp_f32 v106, v106
    v_exp_f32 v107, v107
    v_mfma_f32_32x32x16_bf16 v[128:143], v[32:35], v[40:43], v[128:143]
    v_exp_f32 v108, v108
    v_exp_f32 v109, v109
    v_exp_f32 v110, v110
    v_exp_f32 v111, v111
    v_cvt_pk_bf16_f32 v44, v104, v105
    v_cvt_pk_bf16_f32 v45, v106, v107
    v_cvt_pk_bf16_f32 v46, v108, v109
    v_cvt_pk_bf16_f32 v47, v110, v111
    v_exp_f32 v112, v112
    v_exp_f32 v113, v113
    v_exp_f32 v114, v114
    v_exp_f32 v115, v115
    v_mfma_f32_32x32x16_bf16 v[128:143], v[36:39], v[44:47], v[128:143]
    v_exp_f32 v116, v116
    v_exp_f32 v117, v117
    v_exp_f32 v118, v118
    v_exp_f32 v119, v119
    v_cvt_pk_bf16_f32 v48, v112, v113
    v_cvt_pk_bf16_f32 v49, v114, v115
    v_cvt_pk_bf16_f32 v50, v116, v117
    v_cvt_pk_bf16_f32 v51, v118, v119
    v_mfma_f32_32x32x16_bf16 v[96:111], v[16:19], v[8:11], v[64:79]
    v_exp_f32 v120, v120
    v_exp_f32 v121, v121
    v_exp_f32 v122, v122
    v_exp_f32 v123, v123
    v_mfma_f32_32x32x16_bf16 v[144:159], v[32:35], v[48:51], v[144:159]
    v_exp_f32 v124, v124
    v_exp_f32 v125, v125
    v_exp_f32 v126, v126
    v_exp_f32 v127, v127
    v_cvt_pk_bf16_f32 v52, v120, v121
    v_cvt_pk_bf16_f32 v53, v122, v123
    v_cvt_pk_bf16_f32 v54, v124, v125
    v_cvt_pk_bf16_f32 v55, v126, v127
    v_add_u32 v2, 2048, v2
    v_add_u32 v3, 128, v3
    s_sub_u32 s30, s30, 1
    s_cmp_lg_u32 s30, 0
    s_cbranch_scc1 L_attn_loop
    v_mfma_f32_32x32x16_bf16 v[144:159], v[36:39], v[52:55], v[144:159]
    s_waitcnt lgkmcnt(0)
    s_nop 15
    s_mul_i32 s26, s21, 4608
    s_add_u32 s26, s26, 139552
    v_add_u32 v60, s26, v1
    v_lshrrev_b32 v61, 2, v1
    v_add_u32 v61, s26, v61
    v_mov_b32 v62, 157984
    s_cmp_eq_u32 s22, 0
    s_cbranch_scc1 L_attn_lo
    ds_write_b128 v60, v[128:131]
    ds_write_b128 v60, v[132:135] offset:1024
    ds_write_b32 v61, v136 offset:2048
    ds_write_b128 v60, v[144:147] offset:2304
    ds_write_b128 v60, v[148:151] offset:3328
    ds_write_b32 v61, v152 offset:4352
    s_waitcnt lgkmcnt(0)
    s_barrier
    s_branch L_attn_join
L_attn_lo:
    s_barrier
    ds_read_b128 v[96:99], v60
    ds_read_b128 v[100:103], v60 offset:1024
    ds_read_b32 v104, v61 offset:2048
    ds_read_b128 v[112:115], v60 offset:2304
    ds_read_b128 v[116:119], v60 offset:3328
    ds_read_b32 v120, v61 offset:4352
    s_waitcnt lgkmcnt(0)
    v_add_f32 v128, v128, v96
    v_add_f32 v144, v144, v112
    v_add_f32 v129, v129, v97
    v_add_f32 v145, v145, v113
    v_add_f32 v130, v130, v98
    v_add_f32 v146, v146, v114
    v_add_f32 v131, v131, v99
    v_add_f32 v147, v147, v115
    v_add_f32 v132, v132, v100
    v_add_f32 v148, v148, v116
    v_add_f32 v133, v133, v101
    v_add_f32 v149, v149, v117
    v_add_f32 v134, v134, v102
    v_add_f32 v150, v150, v118
    v_add_f32 v135, v135, v103
    v_add_f32 v151, v151, v119
    v_add_f32 v136, v136, v104
    v_add_f32 v152, v152, v120
    v_mov_b32 v58, v136
    v_mov_b32 v59, v152
    s_mov_b32 s26, 0x1f800000
    s_mov_b32 s27, 0x5f800000
    v_permlane32_swap_b32 v136, v58
    v_permlane32_swap_b32 v152, v59
    s_nop 1
    v_cmp_nle_f32 s[54:55], s26, v136
    v_cmp_nle_f32 s[56:57], s26, v152
    v_cmp_nge_f32 vcc, s27, v136
    s_or_b64 s[54:55], s[54:55], s[56:57]
    s_or_b64 s[54:55], s[54:55], vcc
    v_cmp_nge_f32 vcc, s27, v152
    v_mov_b32 v63, 1
    s_or_b64 s[54:55], s[54:55], vcc
    s_cmp_eq_u64 s[54:55], 0
    s_cbranch_scc1 L_attn_join
    ds_write_b32 v62, v63
    s_waitcnt lgkmcnt(0)
L_attn_join:
    s_barrier
    ds_read_b32 v63, v62
    s_waitcnt lgkmcnt(0)
    v_readfirstlane_b32 s26, v63
    s_cmp_lg_u32 s53, 0
    s_cselect_b32 s26, 0, s26
    s_cmp_lg_u32 s26, 0
    s_cbranch_scc1 L_attn_slow
    s_cmp_lg_u32 s22, 0
    s_cbranch_scc1 L_attn_end
    v_rcp_f32 v58, v136
    v_rcp_f32 v59, v152
    s_nop 0
    v_mul_f32 v128, v128, v58
    v_mul_f32 v144, v144, v59
    v_mul_f32 v129, v129, v58
    v_mul_f32 v145, v145, v59
    v_mul_f32 v130, v130, v58
    v_mul_f32 v146, v146, v59
    v_mul_f32 v131, v131, v58
    v_mul_f32 v147, v147, v59
    v_mul_f32 v132, v132, v58
    v_mul_f32 v148, v148, v59
    v_mul_f32 v133, v133, v58
    v_mul_f32 v149, v149, v59
    v_mul_f32 v134, v134, v58
    v_mul_f32 v150, v150, v59
    v_mul_f32 v135, v135, v58
    v_mul_f32 v151, v151, v59
    v_cvt_pk_bf16_f32 v40, v128, v129
    v_cvt_pk_bf16_f32 v48, v144, v145
    v_cvt_pk_bf16_f32 v41, v130, v131
    v_cvt_pk_bf16_f32 v49, v146, v147
    v_cvt_pk_bf16_f32 v42, v132, v133
    v_cvt_pk_bf16_f32 v50, v148, v149
    v_cvt_pk_bf16_f32 v43, v134, v135
    v_cvt_pk_bf16_f32 v51, v150, v151
    v_and_b32 v6, 31, v0
    v_lshlrev_b32 v6, 5, v6
    v_lshl_or_b32 v6, v7, 3, v6
    s_add_u32 s24, s24, 3145728
    buffer_store_dwordx2 v[40:41], v6, s[8:11], s24 offen
    buffer_store_dwordx2 v[42:43], v6, s[8:11], s24 offen offset:16
    buffer_store_dwordx2 v[48:49], v6, s[8:11], s24 offen offset:1024
    buffer_store_dwordx2 v[50:51], v6, s[8:11], s24 offen offset:1040
    s_branch L_attn_end
L_attn_slow:
    s_mov_b32 s53, 1
    s_lshl_b32 s26, s22, 15
    v_add_u32 v2, s26, v1
    v_mov_b32 v4, 0xff800000
    v_mov_b32 v5, 0xff800000
    s_mov_b32 s30, 32
L_attn_mloop:
    ds_read_b128 v[16:19], v2
    v_add_u32 v2, 1024, v2
    s_waitcnt lgkmcnt(0)
    v_mfma_f32_32x32x16_bf16 v[96:111], v[16:19], v[8:11], 0
    v_mfma_f32_32x32x16_bf16 v[112:127], v[16:19], v[12:15], 0
    s_nop 15
    s_nop 7
    v_max3_f32 v4, v4, v96, v97
    v_max3_f32 v5, v5, v112, v113
    v_max3_f32 v4, v4, v98, v99
    v_max3_f32 v5, v5, v114, v115
    v_max3_f32 v4, v4, v100, v101
    v_max3_f32 v5, v5, v116, v117
    v_max3_f32 v4, v4, v102, v103
    v_max3_f32 v5, v5, v118, v119
    v_max3_f32 v4, v4, v104, v105
    v_max3_f32 v5, v5, v120, v121
    v_max3_f32 v4, v4, v106, v107
    v_max3_f32 v5, v5, v122, v123
    v_max3_f32 v4, v4, v108, v109
    v_max3_f32 v5, v5, v124, v125
    v_max3_f32 v4, v4, v110, v111
    v_max3_f32 v5, v5, v126, v127
    s_sub_u32 s30, s30, 1
    s_cmp_lg_u32 s30, 0
    s_cbranch_scc1 L_attn_mloop
    v_mov_b32 v58, v4
    v_mov_b32 v59, v5
    s_nop 1
    v_permlane32_swap_b32 v4, v58
    v_permlane32_swap_b32 v5, v59
    s_nop 1
    v_max_f32 v4, v4, v58
    v_max_f32 v5, v5, v59
    s_lshl_b32 s26, s22, 9
    v_add_u32 v58, s26, v61
    s_sub_u32 s27, 512, s26
    v_add_u32 v59, s27, v61
    ds_write_b32 v58, v4
    ds_write_b32 v58, v5 offset:256
    s_waitcnt lgkmcnt(0)
    s_barrier
    ds_read_b32 v56, v59
    ds_read_b32 v57, v59 offset:256
    s_waitcnt lgkmcnt(0)
    v_max_f32 v4, v4, v56
    v_max_f32 v5, v5, v57
    s_barrier
    s_branch L_attn_pass
L_attn_end:
    s_endpgm
.globl wo_kernel
.p2align 8
.type wo_kernel,@function
wo_kernel:
    s_cmp_ge_u32 s2, 256
    s_cbranch_scc1 L_wo_kernel_end
    s_load_dwordx2 s[4:5], s[0:1], 0
    s_load_dwordx2 s[6:7], s[0:1], 32
    s_load_dwordx4 s[32:35], s[0:1], 48
    s_load_dwordx2 s[36:37], s[0:1], 88
    v_and_b32 v4, 63, v0
    v_lshrrev_b32 v6, 6, v0
    v_and_b32 v5, 31, v0
    v_readfirstlane_b32 s20, v6
    v_bfe_u32 v7, v0, 5, 1
    s_and_b32 s21, s2, 7
    s_lshl_b32 s21, s21, 2
    s_lshr_b32 s22, s2, 6
    s_add_u32 s21, s21, s22
    s_lshl_b32 s21, s21, 6
    s_bfe_u32 s22, s2, 0x30003
    s_lshl_b32 s22, s22, 6
    s_waitcnt lgkmcnt(0)
    s_mov_b32 s8, s4
    s_mov_b32 s9, s5
    s_mov_b32 s10, 2097152
    s_mov_b32 s11, 0x00020000
    s_mov_b32 s12, s6
    s_mov_b32 s13, s7
    s_mov_b32 s14, 524288
    s_mov_b32 s15, 0x00020000
    s_mov_b32 s16, s36
    s_mov_b32 s17, s37
    s_mov_b32 s18, 268435456
    s_mov_b32 s19, 0x00020000
    s_lshl_b32 s31, s21, 10
    s_lshl_b32 s25, s22, 1
    s_add_u32 s31, s31, s25
    v_lshrrev_b32 v3, 3, v0
    v_and_b32 v6, 7, v0
    v_lshlrev_b32 v3, 10, v3
    v_lshl_add_u32 v3, v6, 4, v3
    s_add_u32 s25, s31, 32768
    buffer_load_dwordx4 v[80:83], v3, s[8:11], s31 offen
    buffer_load_dwordx4 v[84:87], v3, s[8:11], s25 offen
    s_and_b32 s23, s20, 1
    s_lshr_b32 s24, s20, 1
    v_lshrrev_b32 v10, 4, v4
    v_and_b32 v11, 15, v4
    v_lshrrev_b32 v12, 4, v4
    s_lshl_b32 s25, s20, 2
    v_add_u32 v12, s25, v12
    v_and_b32 v12, 15, v12
    v_xor_b32 v11, v11, v12
    s_mov_b32 s25, 1024
    v_mul_lo_u32 v10, v10, s25
    v_lshl_add_u32 v1, v11, 4, v10
    v_lshrrev_b32 v10, 3, v4
    v_and_b32 v11, 7, v4
    v_bfe_u32 v12, v4, 4, 1
    v_lshlrev_b32 v12, 2, v12
    v_xor_b32 v11, v11, v12
    s_mov_b32 s25, 1024
    v_mul_lo_u32 v10, v10, s25
    v_lshl_add_u32 v2, v11, 4, v10
    s_mul_i32 s25, s20, 4
    s_add_u32 s25, s25, s21
    s_mul_i32 s26, s25, 1024
    s_add_u32 s26, s26, 3145728
    s_mul_i32 s27, s20, 8192
    s_lshl_b32 s25, s22, 1
    s_add_u32 s27, s27, s25
    s_lshl_b32 s28, s20, 10
    s_mov_b32 s29, s28
    s_add_u32 s30, s28, 131072
    s_mov_b32 s46, 3
L_wo_kernel_pre:
    s_add_u32 s38, s29, 0
    s_mov_b32 m0, s38
    s_add_u32 s39, s26, 0
    buffer_load_dwordx4 v1, s[16:19], s39 offen lds
    s_add_u32 s38, s29, 4096
    s_mov_b32 m0, s38
    s_add_u32 s39, s26, 16384
    buffer_load_dwordx4 v1, s[16:19], s39 offen lds
    s_add_u32 s38, s29, 8192
    s_mov_b32 m0, s38
    s_add_u32 s39, s26, 32768
    buffer_load_dwordx4 v1, s[16:19], s39 offen lds
    s_add_u32 s38, s29, 12288
    s_mov_b32 m0, s38
    s_add_u32 s39, s26, 49152
    buffer_load_dwordx4 v1, s[16:19], s39 offen lds
    s_add_u32 s38, s29, 16384
    s_mov_b32 m0, s38
    s_add_u32 s39, s27, 0
    buffer_load_dwordx4 v2, s[12:15], s39 offen lds
    s_add_u32 s38, s29, 20480
    s_mov_b32 m0, s38
    s_add_u32 s39, s27, 32768
    buffer_load_dwordx4 v2, s[12:15], s39 offen lds
    s_add_u32 s38, s29, 24576
    s_mov_b32 m0, s38
    s_add_u32 s39, s27, 65536
    buffer_load_dwordx4 v2, s[12:15], s39 offen lds
    s_add_u32 s38, s29, 28672
    s_mov_b32 m0, s38
    s_add_u32 s39, s27, 98304
    buffer_load_dwordx4 v2, s[12:15], s39 offen lds
    s_add_u32 s26, s26, 256
    s_add_u32 s27, s27, 131072
    s_add_u32 s29, s29, 32768
    s_cmp_ge_u32 s29, s30
    s_cselect_b32 s29, s28, s29
    s_sub_u32 s46, s46, 1
    s_cmp_lg_u32 s46, 0
    s_cbranch_scc1 L_wo_kernel_pre
    v_and_b32 v10, 15, v5
    v_xor_b32 v10, v10, v7
    v_lshlrev_b32 v10, 4, v10
    v_lshl_add_u32 v10, v5, 8, v10
    s_mul_i32 s25, s23, 8192
    v_xor_b32 v16, 0, v10
    v_add_u32 v16, s25, v16
    v_xor_b32 v17, 32, v10
    v_add_u32 v17, s25, v17
    v_xor_b32 v18, 64, v10
    v_add_u32 v18, s25, v18
    v_xor_b32 v19, 96, v10
    v_add_u32 v19, s25, v19
    v_xor_b32 v20, 128, v10
    v_add_u32 v20, s25, v20
    v_xor_b32 v21, 160, v10
    v_add_u32 v21, s25, v21
    v_xor_b32 v22, 192, v10
    v_add_u32 v22, s25, v22
    v_xor_b32 v23, 224, v10
    v_add_u32 v23, s25, v23
    v_bfe_u32 v10, v0, 2, 2
    v_lshl_add_u32 v11, v7, 3, v10
    v_lshlrev_b32 v11, 7, v11
    v_bfe_u32 v12, v0, 4, 1
    v_bfe_u32 v13, v0, 1, 1
    v_lshl_add_u32 v12, v12, 1, v13
    v_bfe_u32 v13, v0, 3, 1
    v_lshlrev_b32 v13, 2, v13
    v_xor_b32 v12, v12, v13
    v_lshl_add_u32 v11, v12, 4, v11
    v_and_b32 v13, 1, v0
    v_lshl_add_u32 v14, v13, 3, v11
    s_mul_i32 s25, s24, 1
    s_add_u32 s25, s25, 0
    s_lshl_b32 s25, s25, 6
    v_xor_b32 v32, s25, v14
    v_add_u32 v32, 16384, v32
    v_mov_b32 v64, 0
    v_mov_b32 v65, 0
    v_mov_b32 v66, 0
    v_mov_b32 v67, 0
    v_mov_b32 v68, 0
    v_mov_b32 v69, 0
    v_mov_b32 v70, 0
    v_mov_b32 v71, 0
    v_mov_b32 v72, 0
    v_mov_b32 v73, 0
    v_mov_b32 v74, 0
    v_mov_b32 v75, 0
    v_mov_b32 v76, 0
    v_mov_b32 v77, 0
    v_mov_b32 v78, 0
    v_mov_b32 v79, 0
    v_mov_b32 v44, 0
    v_mov_b32 v45, 0
    v_mov_b32 v46, 0
    v_mov_b32 v47, 0
    v_mov_b32 v48, 0
    v_mov_b32 v49, 0
    v_mov_b32 v50, 0
    v_mov_b32 v51, 0
    s_mov_b32 s47, 0
    s_mov_b32 s46, 1
L_wo_kernel_main:
    v_add_u32 v24, s47, v16
    v_add_u32 v25, s47, v17
    v_add_u32 v26, s47, v18
    v_add_u32 v27, s47, v19
    v_add_u32 v28, s47, v20
    v_add_u32 v29, s47, v21
    v_add_u32 v30, s47, v22
    v_add_u32 v31, s47, v23
    v_add_u32 v33, s47, v32
    s_add_u32 s47, s47, 32768
    s_cmp_ge_u32 s47, 131072
    s_cselect_b32 s47, 0, s47
    s_waitcnt vmcnt(16) lgkmcnt(0)
    s_barrier
    ds_read_b128 v[36:39], v24 offset:0
    ds_read_b64_tr_b16 v[40:41], v33 offset:0
    ds_read_b64_tr_b16 v[42:43], v33 offset:512
    v_mfma_f32_32x32x16_bf16 v[64:79], v[48:51], v[44:47], v[64:79]
    s_add_u32 s38, s29, 0
    s_mov_b32 m0, s38
    s_add_u32 s39, s26, 0
    buffer_load_dwordx4 v1, s[16:19], s39 offen lds
    ds_read_b128 v[44:47], v25 offset:0
    ds_read_b64_tr_b16 v[48:49], v33 offset:2048
    ds_read_b64_tr_b16 v[50:51], v33 offset:2560
    s_waitcnt lgkmcnt(3)
    v_mfma_f32_32x32x16_bf16 v[64:79], v[40:43], v[36:39], v[64:79]
    s_add_u32 s38, s29, 4096
    s_mov_b32 m0, s38
    s_add_u32 s39, s26, 16384
    buffer_load_dwordx4 v1, s[16:19], s39 offen lds
    ds_read_b128 v[36:39], v26 offset:0
    ds_read_b64_tr_b16 v[40:41], v33 offset:4096
    ds_read_b64_tr_b16 v[42:43], v33 offset:4608
    s_waitcnt lgkmcnt(3)
    v_mfma_f32_32x32x16_bf16 v[64:79], v[48:51], v[44:47], v[64:79]
    s_add_u32 s38, s29, 8192
    s_mov_b32 m0, s38
    s_add_u32 s39, s26, 32768
    buffer_load_dwordx4 v1, s[16:19], s39 offen lds
    ds_read_b128 v[44:47], v27 offset:0
    ds_read_b64_tr_b16 v[48:49], v33 offset:6144
    ds_read_b64_tr_b16 v[50:51], v33 offset:6656
    s_waitcnt lgkmcnt(3)
    v_mfma_f32_32x32x16_bf16 v[64:79], v[40:43], v[36:39], v[64:79]
    s_add_u32 s38, s29, 12288
    s_mov_b32 m0, s38
    s_add_u32 s39, s26, 49152
    buffer_load_dwordx4 v1, s[16:19], s39 offen lds
    ds_read_b128 v[36:39], v28 offset:0
    ds_read_b64_tr_b16 v[40:41], v33 offset:8192
    ds_read_b64_tr_b16 v[42:43], v33 offset:8704
    s_waitcnt lgkmcnt(3)
    v_mfma_f32_32x32x16_bf16 v[64:79], v[48:51], v[44:47], v[64:79]
    s_add_u32 s38, s29, 16384
    s_mov_b32 m0, s38
    s_add_u32 s39, s27, 0
    buffer_load_dwordx4 v2, s[12:15], s39 offen lds
    ds_read_b128 v[44:47], v29 offset:0
    ds_read_b64_tr_b16 v[48:49], v33 offset:10240
    ds_read_b64_tr_b16 v[50:51], v33 offset:10752
    s_waitcnt lgkmcnt(3)
    v_mfma_f32_32x32x16_bf16 v[64:79], v[40:43], v[36:39], v[64:79]
    s_add_u32 s38, s29, 20480
    s_mov_b32 m0, s38
    s_add_u32 s39, s27, 32768
    buffer_load_dwordx4 v2, s[12:15], s39 offen lds
    ds_read_b128 v[36:39], v30 offset:0
    ds_read_b64_tr_b16 v[40:41], v33 offset:12288
    ds_read_b64_tr_b16 v[42:43], v33 offset:12800
    s_waitcnt lgkmcnt(3)
    v_mfma_f32_32x32x16_bf16 v[64:79], v[48:51], v[44:47], v[64:79]
    s_add_u32 s38, s29, 24576
    s_mov_b32 m0, s38
    s_add_u32 s39, s27, 65536
    buffer_load_dwordx4 v2, s[12:15], s39 offen lds
    ds_read_b128 v[44:47], v31 offset:0
    ds_read_b64_tr_b16 v[48:49], v33 offset:14336
    ds_read_b64_tr_b16 v[50:51], v33 offset:14848
    s_waitcnt lgkmcnt(3)
    v_mfma_f32_32x32x16_bf16 v[64:79], v[40:43], v[36:39], v[64:79]
    s_add_u32 s38, s29, 28672
    s_mov_b32 m0, s38
    s_add_u32 s39, s27, 98304
    buffer_load_dwordx4 v2, s[12:15], s39 offen lds
    s_add_u32 s26, s26, 256
    s_add_u32 s27, s27, 131072
    s_add_u32 s29, s29, 32768
    s_cmp_ge_u32 s29, s30
    s_cselect_b32 s29, s28, s29
    s_sub_u32 s46, s46, 1
    s_cmp_lg_u32 s46, 0
    s_cbranch_scc1 L_wo_kernel_main
    v_add_u32 v24, s47, v16
    v_add_u32 v25, s47, v17
    v_add_u32 v26, s47, v18
    v_add_u32 v27, s47, v19
    v_add_u32 v28, s47, v20
    v_add_u32 v29, s47, v21
    v_add_u32 v30, s47, v22
    v_add_u32 v31, s47, v23
    v_add_u32 v33, s47, v32
    s_add_u32 s47, s47, 32768
    s_cmp_ge_u32 s47, 131072
    s_cselect_b32 s47, 0, s47
    s_waitcnt vmcnt(16) lgkmcnt(0)
    s_barrier
    ds_read_b128 v[36:39], v24 offset:0
    ds_read_b64_tr_b16 v[40:41], v33 offset:0
    ds_read_b64_tr_b16 v[42:43], v33 offset:512
    v_mfma_f32_32x32x16_bf16 v[64:79], v[48:51], v[44:47], v[64:79]
    ds_read_b128 v[44:47], v25 offset:0
    ds_read_b64_tr_b16 v[48:49], v33 offset:2048
    ds_read_b64_tr_b16 v[50:51], v33 offset:2560
    s_waitcnt lgkmcnt(3)
    v_mfma_f32_32x32x16_bf16 v[64:79], v[40:43], v[36:39], v[64:79]
    ds_read_b128 v[36:39], v26 offset:0
    ds_read_b64_tr_b16 v[40:41], v33 offset:4096
    ds_read_b64_tr_b16 v[42:43], v33 offset:4608
    s_waitcnt lgkmcnt(3)
    v_mfma_f32_32x32x16_bf16 v[64:79], v[48:51], v[44:47], v[64:79]
    ds_read_b128 v[44:47], v27 offset:0
    ds_read_b64_tr_b16 v[48:49], v33 offset:6144
    ds_read_b64_tr_b16 v[50:51], v33 offset:6656
    s_waitcnt lgkmcnt(3)
    v_mfma_f32_32x32x16_bf16 v[64:79], v[40:43], v[36:39], v[64:79]
    ds_read_b128 v[36:39], v28 offset:0
    ds_read_b64_tr_b16 v[40:41], v33 offset:8192
    ds_read_b64_tr_b16 v[42:43], v33 offset:8704
    s_waitcnt lgkmcnt(3)
    v_mfma_f32_32x32x16_bf16 v[64:79], v[48:51], v[44:47], v[64:79]
    ds_read_b128 v[44:47], v29 offset:0
    ds_read_b64_tr_b16 v[48:49], v33 offset:10240
    ds_read_b64_tr_b16 v[50:51], v33 offset:10752
    s_waitcnt lgkmcnt(3)
    v_mfma_f32_32x32x16_bf16 v[64:79], v[40:43], v[36:39], v[64:79]
    ds_read_b128 v[36:39], v30 offset:0
    ds_read_b64_tr_b16 v[40:41], v33 offset:12288
    ds_read_b64_tr_b16 v[42:43], v33 offset:12800
    s_waitcnt lgkmcnt(3)
    v_mfma_f32_32x32x16_bf16 v[64:79], v[48:51], v[44:47], v[64:79]
    ds_read_b128 v[44:47], v31 offset:0
    ds_read_b64_tr_b16 v[48:49], v33 offset:14336
    ds_read_b64_tr_b16 v[50:51], v33 offset:14848
    s_waitcnt lgkmcnt(3)
    v_mfma_f32_32x32x16_bf16 v[64:79], v[40:43], v[36:39], v[64:79]
    v_add_u32 v24, s47, v16
    v_add_u32 v25, s47, v17
    v_add_u32 v26, s47, v18
    v_add_u32 v27, s47, v19
    v_add_u32 v28, s47, v20
    v_add_u32 v29, s47, v21
    v_add_u32 v30, s47, v22
    v_add_u32 v31, s47, v23
    v_add_u32 v33, s47, v32
    s_add_u32 s47, s47, 32768
    s_cmp_ge_u32 s47, 131072
    s_cselect_b32 s47, 0, s47
    s_waitcnt vmcnt(8) lgkmcnt(0)
    s_barrier
    ds_read_b128 v[36:39], v24 offset:0
    ds_read_b64_tr_b16 v[40:41], v33 offset:0
    ds_read_b64_tr_b16 v[42:43], v33 offset:512
    v_mfma_f32_32x32x16_bf16 v[64:79], v[48:51], v[44:47], v[64:79]
    ds_read_b128 v[44:47], v25 offset:0
    ds_read_b64_tr_b16 v[48:49], v33 offset:2048
    ds_read_b64_tr_b16 v[50:51], v33 offset:2560
    s_waitcnt lgkmcnt(3)
    v_mfma_f32_32x32x16_bf16 v[64:79], v[40:43], v[36:39], v[64:79]
    ds_read_b128 v[36:39], v26 offset:0
    ds_read_b64_tr_b16 v[40:41], v33 offset:4096
    ds_read_b64_tr_b16 v[42:43], v33 offset:4608
    s_waitcnt lgkmcnt(3)
    v_mfma_f32_32x32x16_bf16 v[64:79], v[48:51], v[44:47], v[64:79]
    ds_read_b128 v[44:47], v27 offset:0
    ds_read_b64_tr_b16 v[48:49], v33 offset:6144
    ds_read_b64_tr_b16 v[50:51], v33 offset:6656
    s_waitcnt lgkmcnt(3)
    v_mfma_f32_32x32x16_bf16 v[64:79], v[40:43], v[36:39], v[64:79]
    ds_read_b128 v[36:39], v28 offset:0
    ds_read_b64_tr_b16 v[40:41], v33 offset:8192
    ds_read_b64_tr_b16 v[42:43], v33 offset:8704
    s_waitcnt lgkmcnt(3)
    v_mfma_f32_32x32x16_bf16 v[64:79], v[48:51], v[44:47], v[64:79]
    ds_read_b128 v[44:47], v29 offset:0
    ds_read_b64_tr_b16 v[48:49], v33 offset:10240
    ds_read_b64_tr_b16 v[50:51], v33 offset:10752
    s_waitcnt lgkmcnt(3)
    v_mfma_f32_32x32x16_bf16 v[64:79], v[40:43], v[36:39], v[64:79]
    ds_read_b128 v[36:39], v30 offset:0
    ds_read_b64_tr_b16 v[40:41], v33 offset:12288
    ds_read_b64_tr_b16 v[42:43], v33 offset:12800
    s_waitcnt lgkmcnt(3)
    v_mfma_f32_32x32x16_bf16 v[64:79], v[48:51], v[44:47], v[64:79]
    ds_read_b128 v[44:47], v31 offset:0
    ds_read_b64_tr_b16 v[48:49], v33 offset:14336
    ds_read_b64_tr_b16 v[50:51], v33 offset:14848
    s_waitcnt lgkmcnt(3)
    v_mfma_f32_32x32x16_bf16 v[64:79], v[40:43], v[36:39], v[64:79]
    v_add_u32 v24, s47, v16
    v_add_u32 v25, s47, v17
    v_add_u32 v26, s47, v18
    v_add_u32 v27, s47, v19
    v_add_u32 v28, s47, v20
    v_add_u32 v29, s47, v21
    v_add_u32 v30, s47, v22
    v_add_u32 v31, s47, v23
    v_add_u32 v33, s47, v32
    s_add_u32 s47, s47, 32768
    s_cmp_ge_u32 s47, 131072
    s_cselect_b32 s47, 0, s47
    s_waitcnt vmcnt(0) lgkmcnt(0)
    s_barrier
    ds_read_b128 v[36:39], v24 offset:0
    ds_read_b64_tr_b16 v[40:41], v33 offset:0
    ds_read_b64_tr_b16 v[42:43], v33 offset:512
    v_mfma_f32_32x32x16_bf16 v[64:79], v[48:51], v[44:47], v[64:79]
    ds_read_b128 v[44:47], v25 offset:0
    ds_read_b64_tr_b16 v[48:49], v33 offset:2048
    ds_read_b64_tr_b16 v[50:51], v33 offset:2560
    s_waitcnt lgkmcnt(3)
    v_mfma_f32_32x32x16_bf16 v[64:79], v[40:43], v[36:39], v[64:79]
    ds_read_b128 v[36:39], v26 offset:0
    ds_read_b64_tr_b16 v[40:41], v33 offset:4096
    ds_read_b64_tr_b16 v[42:43], v33 offset:4608
    s_waitcnt lgkmcnt(3)
    v_mfma_f32_32x32x16_bf16 v[64:79], v[48:51], v[44:47], v[64:79]
    ds_read_b128 v[44:47], v27 offset:0
    ds_read_b64_tr_b16 v[48:49], v33 offset:6144
    ds_read_b64_tr_b16 v[50:51], v33 offset:6656
    s_waitcnt lgkmcnt(3)
    v_mfma_f32_32x32x16_bf16 v[64:79], v[40:43], v[36:39], v[64:79]
    ds_read_b128 v[36:39], v28 offset:0
    ds_read_b64_tr_b16 v[40:41], v33 offset:8192
    ds_read_b64_tr_b16 v[42:43], v33 offset:8704
    s_waitcnt lgkmcnt(3)
    v_mfma_f32_32x32x16_bf16 v[64:79], v[48:51], v[44:47], v[64:79]
    ds_read_b128 v[44:47], v29 offset:0
    ds_read_b64_tr_b16 v[48:49], v33 offset:10240
    ds_read_b64_tr_b16 v[50:51], v33 offset:10752
    s_waitcnt lgkmcnt(3)
    v_mfma_f32_32x32x16_bf16 v[64:79], v[40:43], v[36:39], v[64:79]
    ds_read_b128 v[36:39], v30 offset:0
    ds_read_b64_tr_b16 v[40:41], v33 offset:12288
    ds_read_b64_tr_b16 v[42:43], v33 offset:12800
    s_waitcnt lgkmcnt(3)
    v_mfma_f32_32x32x16_bf16 v[64:79], v[48:51], v[44:47], v[64:79]
    ds_read_b128 v[44:47], v31 offset:0
    ds_read_b64_tr_b16 v[48:49], v33 offset:14336
    ds_read_b64_tr_b16 v[50:51], v33 offset:14848
    s_waitcnt lgkmcnt(3)
    v_mfma_f32_32x32x16_bf16 v[64:79], v[40:43], v[36:39], v[64:79]
    s_waitcnt lgkmcnt(0)
    v_mfma_f32_32x32x16_bf16 v[64:79], v[48:51], v[44:47], v[64:79]
    s_nop 15
    s_lshl_b32 s25, s23, 5
    v_add_u32 v10, s25, v5
    s_movk_i32 s25, 272
    v_mul_lo_u32 v10, v10, s25
    v_lshl_add_u32 v10, v7, 4, v10
    s_lshl_b32 s25, s24, 7
    v_add_u32 v10, s25, v10
    ds_write_b128 v10, v[64:67] offset:0
    ds_write_b128 v10, v[68:71] offset:32
    ds_write_b128 v10, v[72:75] offset:64
    ds_write_b128 v10, v[76:79] offset:96
    v_lshrrev_b32 v10, 3, v0
    s_movk_i32 s25, 272
    v_mul_lo_u32 v10, v10, s25
    v_lshl_add_u32 v10, v6, 5, v10
    s_waitcnt lgkmcnt(0)
    s_barrier
    ds_read_b128 v[64:67], v10 offset:0
    ds_read_b128 v[68:71], v10 offset:16
    ds_read_b128 v[72:75], v10 offset:8704
    ds_read_b128 v[76:79], v10 offset:8720
    s_waitcnt vmcnt(0) lgkmcnt(0)
    v_lshlrev_b32 v12, 16, v80
    v_and_b32 v13, 0xffff0000, v80
    v_add_f32 v64, v64, v12
    v_add_f32 v65, v65, v13
    v_lshlrev_b32 v12, 16, v81
    v_and_b32 v13, 0xffff0000, v81
    v_add_f32 v66, v66, v12
    v_add_f32 v67, v67, v13
    v_lshlrev_b32 v12, 16, v82
    v_and_b32 v13, 0xffff0000, v82
    v_add_f32 v68, v68, v12
    v_add_f32 v69, v69, v13
    v_lshlrev_b32 v12, 16, v83
    v_and_b32 v13, 0xffff0000, v83
    v_add_f32 v70, v70, v12
    v_add_f32 v71, v71, v13
    v_lshlrev_b32 v12, 16, v84
    v_and_b32 v13, 0xffff0000, v84
    v_add_f32 v72, v72, v12
    v_add_f32 v73, v73, v13
    v_lshlrev_b32 v12, 16, v85
    v_and_b32 v13, 0xffff0000, v85
    v_add_f32 v74, v74, v12
    v_add_f32 v75, v75, v13
    v_lshlrev_b32 v12, 16, v86
    v_and_b32 v13, 0xffff0000, v86
    v_add_f32 v76, v76, v12
    v_add_f32 v77, v77, v13
    v_lshlrev_b32 v12, 16, v87
    v_and_b32 v13, 0xffff0000, v87
    v_add_f32 v78, v78, v12
    v_add_f32 v79, v79, v13
    v_cvt_pk_bf16_f32 v64, v64, v65
    v_cvt_pk_bf16_f32 v65, v66, v67
    v_cvt_pk_bf16_f32 v66, v68, v69
    v_cvt_pk_bf16_f32 v67, v70, v71
    v_cvt_pk_bf16_f32 v68, v72, v73
    v_cvt_pk_bf16_f32 v69, v74, v75
    v_cvt_pk_bf16_f32 v70, v76, v77
    v_cvt_pk_bf16_f32 v71, v78, v79
    s_add_u32 s25, s31, 5242880
    buffer_store_dwordx4 v[64:67], v3, s[16:19], s25 offen
    s_add_u32 s25, s31, 5275648
    buffer_store_dwordx4 v[68:71], v3, s[16:19], s25 offen
    v_mov_b32 v80, 0
    v_mov_b32 v81, 0
    v_mov_b32 v82, 0
    v_mov_b32 v83, 0
    v_mov_b32 v15, 0x3f803f80
    v_dot2_f32_bf16 v80, v64, v15, v80
    v_dot2_f32_bf16 v81, v64, v64, v81
    v_dot2_f32_bf16 v82, v68, v15, v82
    v_dot2_f32_bf16 v83, v68, v68, v83
    v_dot2_f32_bf16 v80, v65, v15, v80
    v_dot2_f32_bf16 v81, v65, v65, v81
    v_dot2_f32_bf16 v82, v69, v15, v82
    v_dot2_f32_bf16 v83, v69, v69, v83
    v_dot2_f32_bf16 v80, v66, v15, v80
    v_dot2_f32_bf16 v81, v66, v66, v81
    v_dot2_f32_bf16 v82, v70, v15, v82
    v_dot2_f32_bf16 v83, v70, v70, v83
    v_dot2_f32_bf16 v80, v67, v15, v80
    v_dot2_f32_bf16 v81, v67, v67, v81
    v_dot2_f32_bf16 v82, v71, v15, v82
    v_dot2_f32_bf16 v83, v71, v71, v83
    s_nop 2
    v_add_f32_dpp v80, v80, v80 quad_perm:[1,0,3,2] row_mask:0xf bank_mask:0xf
    v_add_f32_dpp v81, v81, v81 quad_perm:[1,0,3,2] row_mask:0xf bank_mask:0xf
    v_add_f32_dpp v82, v82, v82 quad_perm:[1,0,3,2] row_mask:0xf bank_mask:0xf
    v_add_f32_dpp v83, v83, v83 quad_perm:[1,0,3,2] row_mask:0xf bank_mask:0xf
    s_nop 1
    v_add_f32_dpp v80, v80, v80 quad_perm:[2,3,0,1] row_mask:0xf bank_mask:0xf
    v_add_f32_dpp v81, v81, v81 quad_perm:[2,3,0,1] row_mask:0xf bank_mask:0xf
    v_add_f32_dpp v82, v82, v82 quad_perm:[2,3,0,1] row_mask:0xf bank_mask:0xf
    v_add_f32_dpp v83, v83, v83 quad_perm:[2,3,0,1] row_mask:0xf bank_mask:0xf
    s_nop 1
    v_add_f32_dpp v80, v80, v80 row_half_mirror row_mask:0xf bank_mask:0xf
    v_add_f32_dpp v81, v81, v81 row_half_mirror row_mask:0xf bank_mask:0xf
    v_add_f32_dpp v82, v82, v82 row_half_mirror row_mask:0xf bank_mask:0xf
    v_add_f32_dpp v83, v83, v83 row_half_mirror row_mask:0xf bank_mask:0xf
    s_nop 1
    v_lshrrev_b32 v10, 3, v0
    v_lshlrev_b32 v10, 3, v10
    s_lshl_b32 s38, s21, 3
    s_lshl_b32 s39, s22, 8
    s_add_u32 s38, s38, s39
    s_add_u32 s38, s38, 2293760
    buffer_store_dwordx2 v[80:81], v10, s[16:19], s38 offen
    buffer_store_dwordx2 v[82:83], v10, s[16:19], s38 offen offset:256
L_wo_kernel_end:
    s_endpgm
.globl ffn_kernel
.p2align 8
.type ffn_kernel,@function
ffn_kernel:
    s_cmp_ge_u32 s2, 224
    s_cbranch_scc1 L_ffn_kernel_end
    s_load_dwordx4 s[4:7], s[0:1], 48
    s_load_dwordx2 s[36:37], s[0:1], 88
    v_and_b32 v4, 63, v0
    v_lshrrev_b32 v6, 6, v0
    v_and_b32 v5, 31, v0
    v_readfirstlane_b32 s20, v6
    v_bfe_u32 v7, v0, 5, 1
    s_waitcnt lgkmcnt(0)
    s_mov_b32 s8, s4
    s_mov_b32 s9, s5
    s_mov_b32 s10, 1835008
    s_mov_b32 s11, 0x00020000
    s_mov_b32 s12, s6
    s_mov_b32 s13, s7
    s_mov_b32 s14, 1835008
    s_mov_b32 s15, 0x00020000
    s_mov_b32 s16, s36
    s_mov_b32 s17, s37
    s_mov_b32 s18, 268435456
    s_mov_b32 s19, 0x00020000
    s_and_b32 s21, s2, 7
    s_mul_i32 s21, s21, 28
    s_lshr_b32 s22, s2, 3
    s_add_u32 s21, s21, s22
    s_lshr_b32 s22, s21, 4
    s_and_b32 s21, s21, 15
    s_lshl_b32 s21, s21, 7
    s_lshl_b32 s22, s22, 7
    s_lshr_b32 s33, s20, 2
    v_lshlrev_b32 v3, 4, v4
    s_lshl_b32 s25, s20, 10
    s_add_u32 s38, s25, 147456
    s_mov_b32 m0, s38
    s_lshl_b32 s25, s20, 14
    s_lshl_b32 s39, s21, 3
    s_add_u32 s39, s39, s25
    s_add_u32 s39, s39, 2293760
    buffer_load_dwordx4 v3, s[16:19], s39 offen lds
    v_lshlrev_b32 v3, 4, v5
    s_movk_i32 s25, 7168
    v_mad_u32_u24 v3, v7, s25, v3
    s_mov_b32 m0, 155648
    s_lshl_b32 s39, s22, 2
    s_add_u32 s39, s39, 2232320
    buffer_load_dwordx4 v3, s[16:19], s39 offen lds
    s_and_b32 s23, s20, 1
    s_lshr_b32 s24, s20, 1
    v_lshrrev_b32 v10, 3, v4
    v_and_b32 v11, 7, v4
    v_lshrrev_b32 v12, 4, v4
    s_lshl_b32 s25, s20, 2
    v_add_u32 v12, s25, v12
    v_and_b32 v12, 7, v12
    v_xor_b32 v11, v11, v12
    s_mov_b32 s25, 1024
    v_mul_lo_u32 v10, v10, s25
    v_lshl_add_u32 v1, v11, 4, v10
    v_lshrrev_b32 v10, 4, v4
    v_and_b32 v11, 15, v4
    v_bfe_u32 v12, v4, 4, 2
    v_lshlrev_b32 v12, 2, v12
    v_xor_b32 v11, v11, v12
    s_mov_b32 s25, 3584
    v_mul_lo_u32 v10, v10, s25
    v_lshl_add_u32 v2, v11, 4, v10
    s_mul_i32 s25, s20, 8
    s_add_u32 s25, s25, s21
    s_mul_i32 s26, s25, 1024
    s_add_u32 s26, s26, 5242880
    s_mul_i32 s27, s20, 14336
    s_lshl_b32 s25, s22, 1
    s_add_u32 s27, s27, s25
    s_lshl_b32 s28, s20, 10
    s_mov_b32 s29, s28
    s_add_u32 s30, s28, 147456
    s_mov_b32 s46, 2
L_ffn_kernel_pre:
    s_add_u32 s38, s29, 0
    s_mov_b32 m0, s38
    s_add_u32 s39, s26, 0
    buffer_load_dwordx4 v1, s[16:19], s39 offen lds
    s_add_u32 s38, s29, 8192
    s_mov_b32 m0, s38
    s_add_u32 s39, s26, 65536
    buffer_load_dwordx4 v1, s[16:19], s39 offen lds
    s_add_u32 s38, s29, 16384
    s_mov_b32 m0, s38
    s_add_u32 s39, s27, 0
    buffer_load_dwordx4 v2, s[8:11], s39 offen lds
    s_add_u32 s38, s29, 24576
    s_mov_b32 m0, s38
    s_add_u32 s39, s27, 114688
    buffer_load_dwordx4 v2, s[8:11], s39 offen lds
    s_add_u32 s38, s29, 32768
    s_mov_b32 m0, s38
    s_add_u32 s39, s27, 0
    buffer_load_dwordx4 v2, s[12:15], s39 offen lds
    s_add_u32 s38, s29, 40960
    s_mov_b32 m0, s38
    s_add_u32 s39, s27, 114688
    buffer_load_dwordx4 v2, s[12:15], s39 offen lds
    s_add_u32 s26, s26, 128
    s_add_u32 s27, s27, 229376
    s_add_u32 s29, s29, 49152
    s_cmp_ge_u32 s29, s30
    s_cselect_b32 s29, s28, s29
    s_sub_u32 s46, s46, 1
    s_cmp_lg_u32 s46, 0
    s_cbranch_scc1 L_ffn_kernel_pre
    v_bfe_u32 v10, v5, 1, 3
    v_xor_b32 v10, v10, v7
    v_lshlrev_b32 v10, 4, v10
    v_lshl_add_u32 v10, v5, 7, v10
    s_mul_i32 s25, s23, 8192
    v_xor_b32 v16, 0, v10
    v_add_u32 v16, s25, v16
    v_xor_b32 v17, 32, v10
    v_add_u32 v17, s25, v17
    v_xor_b32 v18, 64, v10
    v_add_u32 v18, s25, v18
    v_xor_b32 v19, 96, v10
    v_add_u32 v19, s25, v19
    v_bfe_u32 v10, v0, 2, 2
    v_lshl_add_u32 v11, v7, 3, v10
    v_lshlrev_b32 v11, 8, v11
    v_bfe_u32 v12, v0, 4, 1
    v_bfe_u32 v13, v0, 1, 1
    v_lshl_add_u32 v12, v12, 1, v13
    v_lshlrev_b32 v13, 2, v10
    v_xor_b32 v12, v12, v13
    v_lshl_add_u32 v11, v12, 4, v11
    v_and_b32 v13, 1, v0
    v_lshl_add_u32 v14, v13, 3, v11
    s_mul_i32 s25, s24, 1
    s_add_u32 s25, s25, 0
    s_lshl_b32 s25, s25, 6
    v_xor_b32 v32, s25, v14
    v_add_u32 v32, 16384, v32
    s_lshl_b32 s25, s23, 9
    v_lshlrev_b32 v3, 3, v5
    v_lshl_add_u32 v3, v7, 12, v3
    v_add_u32 v3, s25, v3
    v_add_u32 v3, 147456, v3
    s_lshl_b32 s25, s24, 7
    v_lshlrev_b32 v6, 4, v7
    v_add_u32 v6, s25, v6
    v_add_u32 v6, 155648, v6
    s_waitcnt vmcnt(12)
    s_barrier
    ds_read_b64 v[136:137], v3 offset:0
    ds_read_b64 v[138:139], v3 offset:1024
    ds_read_b64 v[140:141], v3 offset:2048
    ds_read_b64 v[142:143], v3 offset:3072
    ds_read_b64 v[144:145], v3 offset:256
    ds_read_b64 v[146:147], v3 offset:1280
    ds_read_b64 v[148:149], v3 offset:2304
    ds_read_b64 v[150:151], v3 offset:3328
    ds_read_b128 v[152:155], v6 offset:0
    ds_read_b128 v[156:159], v6 offset:32
    ds_read_b128 v[160:163], v6 offset:64
    ds_read_b128 v[164:167], v6 offset:96
    ds_read_b128 v[168:171], v6 offset:512
    ds_read_b128 v[172:175], v6 offset:544
    ds_read_b128 v[176:179], v6 offset:576
    ds_read_b128 v[180:183], v6 offset:608
    s_waitcnt lgkmcnt(8)
    v_add_f32 v136, v136, v138
    v_add_f32 v137, v137, v139
    v_add_f32 v136, v136, v140
    v_add_f32 v137, v137, v141
    v_add_f32 v136, v136, v142
    v_add_f32 v137, v137, v143
    v_add_f32 v144, v144, v146
    v_add_f32 v145, v145, v147
    v_add_f32 v144, v144, v148
    v_add_f32 v145, v145, v149
    v_add_f32 v144, v144, v150
    v_add_f32 v145, v145, v151
    v_mov_b32 v10, v136
    v_mov_b32 v11, v137
    v_mov_b32 v12, v144
    v_mov_b32 v13, v145
    s_nop 1
    v_permlane32_swap_b32 v136, v10
    v_permlane32_swap_b32 v137, v11
    v_permlane32_swap_b32 v144, v12
    v_permlane32_swap_b32 v145, v13
    s_nop 1
    v_add_f32 v136, v136, v10
    v_add_f32 v137, v137, v11
    v_add_f32 v144, v144, v12
    v_add_f32 v145, v145, v13
    s_waitcnt lgkmcnt(0)
    v_mul_f32 v12, 0xbb000000, v136
    v_mul_f32 v13, 0x3b000000, v137
    v_fma_f32 v13, -v12, v12, v13
    v_max_f32 v13, 0, v13
    v_add_f32 v186, 0x3727c5ac, v13
    v_rsq_f32 v13, v186
    s_nop 0
    v_mul_f32 v184, 0xc0135761, v13
    v_mul_f32 v185, v13, v13
    v_mul_f32 v185, v185, v184
    v_mul_f32 v185, 0x3d372713, v185
    v_mul_f32 v72, v12, v152
    v_mul_f32 v104, v12, v168
    v_mul_f32 v73, v12, v153
    v_mul_f32 v105, v12, v169
    v_mul_f32 v74, v12, v154
    v_mul_f32 v106, v12, v170
    v_mul_f32 v75, v12, v155
    v_mul_f32 v107, v12, v171
    v_mul_f32 v76, v12, v156
    v_mul_f32 v108, v12, v172
    v_mul_f32 v77, v12, v157
    v_mul_f32 v109, v12, v173
    v_mul_f32 v78, v12, v158
    v_mul_f32 v110, v12, v174
    v_mul_f32 v79, v12, v159
    v_mul_f32 v111, v12, v175
    v_mul_f32 v80, v12, v160
    v_mul_f32 v112, v12, v176
    v_mul_f32 v81, v12, v161
    v_mul_f32 v113, v12, v177
    v_mul_f32 v82, v12, v162
    v_mul_f32 v114, v12, v178
    v_mul_f32 v83, v12, v163
    v_mul_f32 v115, v12, v179
    v_mul_f32 v84, v12, v164
    v_mul_f32 v116, v12, v180
    v_mul_f32 v85, v12, v165
    v_mul_f32 v117, v12, v181
    v_mul_f32 v86, v12, v166
    v_mul_f32 v118, v12, v182
    v_mul_f32 v87, v12, v167
    v_mul_f32 v119, v12, v183
    v_mul_f32 v12, 0xbb000000, v144
    v_mul_f32 v13, 0x3b000000, v145
    v_fma_f32 v13, -v12, v12, v13
    v_max_f32 v13, 0, v13
    v_add_f32 v190, 0x3727c5ac, v13
    v_rsq_f32 v13, v190
    s_nop 0
    v_mul_f32 v188, 0xc0135761, v13
    v_mul_f32 v189, v13, v13
    v_mul_f32 v189, v189, v188
    v_mul_f32 v189, 0x3d372713, v189
    v_mul_f32 v88, v12, v152
    v_mul_f32 v120, v12, v168
    v_mul_f32 v89, v12, v153
    v_mul_f32 v121, v12, v169
    v_mul_f32 v90, v12, v154
    v_mul_f32 v122, v12, v170
    v_mul_f32 v91, v12, v155
    v_mul_f32 v123, v12, v171
    v_mul_f32 v92, v12, v156
    v_mul_f32 v124, v12, v172
    v_mul_f32 v93, v12, v157
    v_mul_f32 v125, v12, v173
    v_mul_f32 v94, v12, v158
    v_mul_f32 v126, v12, v174
    v_mul_f32 v95, v12, v159
    v_mul_f32 v127, v12, v175
    v_mul_f32 v96, v12, v160
    v_mul_f32 v128, v12, v176
    v_mul_f32 v97, v12, v161
    v_mul_f32 v129, v12, v177
    v_mul_f32 v98, v12, v162
    v_mul_f32 v130, v12, v178
    v_mul_f32 v99, v12, v163
    v_mul_f32 v131, v12, v179
    v_mul_f32 v100, v12, v164
    v_mul_f32 v132, v12, v180
    v_mul_f32 v101, v12, v165
    v_mul_f32 v133, v12, v181
    v_mul_f32 v102, v12, v166
    v_mul_f32 v134, v12, v182
    v_mul_f32 v103, v12, v167
    v_mul_f32 v135, v12, v183
    v_mov_b32 v52, 0
    v_mov_b32 v53, 0
    v_mov_b32 v54, 0
    v_mov_b32 v55, 0
    v_mov_b32 v56, 0
    v_mov_b32 v57, 0
    v_mov_b32 v58, 0
    v_mov_b32 v59, 0
    v_mov_b32 v60, 0
    v_mov_b32 v61, 0
    v_mov_b32 v62, 0
    v_mov_b32 v63, 0
    v_mov_b32 v64, 0
    v_mov_b32 v65, 0
    v_mov_b32 v66, 0
    v_mov_b32 v67, 0
    s_mov_b32 s47, 0
    s_mov_b32 s46, 6
L_ffn_kernel_main:
    v_add_u32 v24, s47, v16
    v_add_u32 v25, s47, v17
    v_add_u32 v26, s47, v18
    v_add_u32 v27, s47, v19
    v_add_u32 v33, s47, v32
    s_add_u32 s47, s47, 49152
    s_cmp_ge_u32 s47, 147456
    s_cselect_b32 s47, 0, s47
    s_waitcnt vmcnt(6) lgkmcnt(0)
    s_barrier
    ds_read_b128 v[36:39], v24 offset:0
    ds_read_b128 v[40:43], v24 offset:4096
    ds_read_b64_tr_b16 v[44:45], v33 offset:0
    ds_read_b64_tr_b16 v[46:47], v33 offset:1024
    ds_read_b64_tr_b16 v[48:49], v33 offset:16384
    ds_read_b64_tr_b16 v[50:51], v33 offset:17408
    v_mfma_f32_32x32x16_bf16 v[72:87], v[60:63], v[52:55], v[72:87]
    v_mfma_f32_32x32x16_bf16 v[88:103], v[60:63], v[56:59], v[88:103]
    v_mfma_f32_32x32x16_bf16 v[104:119], v[64:67], v[52:55], v[104:119]
    v_mfma_f32_32x32x16_bf16 v[120:135], v[64:67], v[56:59], v[120:135]
    s_cmp_lg_u32 s33, 0
    s_cbranch_scc1 L_ffn_kernel_sg_m_0
    s_add_u32 s38, s29, 0
    s_mov_b32 m0, s38
    s_add_u32 s39, s26, 0
    buffer_load_dwordx4 v1, s[16:19], s39 offen lds
    s_add_u32 s38, s29, 8192
    s_mov_b32 m0, s38
    s_add_u32 s39, s26, 65536
    buffer_load_dwordx4 v1, s[16:19], s39 offen lds
    s_add_u32 s38, s29, 16384
    s_mov_b32 m0, s38
    s_add_u32 s39, s27, 0
    buffer_load_dwordx4 v2, s[8:11], s39 offen lds
L_ffn_kernel_sg_m_0:
    ds_read_b128 v[52:55], v25 offset:0
    ds_read_b128 v[56:59], v25 offset:4096
    ds_read_b64_tr_b16 v[60:61], v33 offset:4096
    ds_read_b64_tr_b16 v[62:63], v33 offset:5120
    ds_read_b64_tr_b16 v[64:65], v33 offset:20480
    ds_read_b64_tr_b16 v[66:67], v33 offset:21504
    s_waitcnt lgkmcnt(6)
    v_mfma_f32_32x32x16_bf16 v[72:87], v[44:47], v[36:39], v[72:87]
    v_mfma_f32_32x32x16_bf16 v[88:103], v[44:47], v[40:43], v[88:103]
    v_mfma_f32_32x32x16_bf16 v[104:119], v[48:51], v[36:39], v[104:119]
    v_mfma_f32_32x32x16_bf16 v[120:135], v[48:51], v[40:43], v[120:135]
    s_cmp_lg_u32 s33, 0
    s_cbranch_scc1 L_ffn_kernel_sg_m_1
    s_add_u32 s38, s29, 24576
    s_mov_b32 m0, s38
    s_add_u32 s39, s27, 114688
    buffer_load_dwordx4 v2, s[8:11], s39 offen lds
    s_add_u32 s38, s29, 32768
    s_mov_b32 m0, s38
    s_add_u32 s39, s27, 0
    buffer_load_dwordx4 v2, s[12:15], s39 offen lds
    s_add_u32 s38, s29, 40960
    s_mov_b32 m0, s38
    s_add_u32 s39, s27, 114688
    buffer_load_dwordx4 v2, s[12:15], s39 offen lds
L_ffn_kernel_sg_m_1:
    ds_read_b128 v[36:39], v26 offset:0
    ds_read_b128 v[40:43], v26 offset:4096
    ds_read_b64_tr_b16 v[44:45], v33 offset:8192
    ds_read_b64_tr_b16 v[46:47], v33 offset:9216
    ds_read_b64_tr_b16 v[48:49], v33 offset:24576
    ds_read_b64_tr_b16 v[50:51], v33 offset:25600
    s_waitcnt lgkmcnt(6)
    v_mfma_f32_32x32x16_bf16 v[72:87], v[60:63], v[52:55], v[72:87]
    v_mfma_f32_32x32x16_bf16 v[88:103], v[60:63], v[56:59], v[88:103]
    v_mfma_f32_32x32x16_bf16 v[104:119], v[64:67], v[52:55], v[104:119]
    v_mfma_f32_32x32x16_bf16 v[120:135], v[64:67], v[56:59], v[120:135]
    s_cmp_lg_u32 s33, 1
    s_cbranch_scc1 L_ffn_kernel_sg_m_2
    s_add_u32 s38, s29, 0
    s_mov_b32 m0, s38
    s_add_u32 s39, s26, 0
    buffer_load_dwordx4 v1, s[16:19], s39 offen lds
    s_add_u32 s38, s29, 8192
    s_mov_b32 m0, s38
    s_add_u32 s39, s26, 65536
    buffer_load_dwordx4 v1, s[16:19], s39 offen lds
    s_add_u32 s38, s29, 16384
    s_mov_b32 m0, s38
    s_add_u32 s39, s27, 0
    buffer_load_dwordx4 v2, s[8:11], s39 offen lds
L_ffn_kernel_sg_m_2:
    ds_read_b128 v[52:55], v27 offset:0
    ds_read_b128 v[56:59], v27 offset:4096
    ds_read_b64_tr_b16 v[60:61], v33 offset:12288
    ds_read_b64_tr_b16 v[62:63], v33 offset:13312
    ds_read_b64_tr_b16 v[64:65], v33 offset:28672
    ds_read_b64_tr_b16 v[66:67], v33 offset:29696
    s_waitcnt lgkmcnt(6)
    v_mfma_f32_32x32x16_bf16 v[72:87], v[44:47], v[36:39], v[72:87]
    v_mfma_f32_32x32x16_bf16 v[88:103], v[44:47], v[40:43], v[88:103]
    v_mfma_f32_32x32x16_bf16 v[104:119], v[48:51], v[36:39], v[104:119]
    v_mfma_f32_32x32x16_bf16 v[120:135], v[48:51], v[40:43], v[120:135]
    s_cmp_lg_u32 s33, 1
    s_cbranch_scc1 L_ffn_kernel_sg_m_3
    s_add_u32 s38, s29, 24576
    s_mov_b32 m0, s38
    s_add_u32 s39, s27, 114688
    buffer_load_dwordx4 v2, s[8:11], s39 offen lds
    s_add_u32 s38, s29, 32768
    s_mov_b32 m0, s38
    s_add_u32 s39, s27, 0
    buffer_load_dwordx4 v2, s[12:15], s39 offen lds
    s_add_u32 s38, s29, 40960
    s_mov_b32 m0, s38
    s_add_u32 s39, s27, 114688
    buffer_load_dwordx4 v2, s[12:15], s39 offen lds
L_ffn_kernel_sg_m_3:
    s_add_u32 s26, s26, 128
    s_add_u32 s27, s27, 229376
    s_add_u32 s29, s29, 49152
    s_cmp_ge_u32 s29, s30
    s_cselect_b32 s29, s28, s29
    s_sub_u32 s46, s46, 1
    s_cmp_lg_u32 s46, 0
    s_cbranch_scc1 L_ffn_kernel_main
    v_add_u32 v24, s47, v16
    v_add_u32 v25, s47, v17
    v_add_u32 v26, s47, v18
    v_add_u32 v27, s47, v19
    v_add_u32 v33, s47, v32
    s_add_u32 s47, s47, 49152
    s_cmp_ge_u32 s47, 147456
    s_cselect_b32 s47, 0, s47
    s_waitcnt vmcnt(6) lgkmcnt(0)
    s_barrier
    ds_read_b128 v[36:39], v24 offset:0
    ds_read_b128 v[40:43], v24 offset:4096
    ds_read_b64_tr_b16 v[44:45], v33 offset:0
    ds_read_b64_tr_b16 v[46:47], v33 offset:1024
    ds_read_b64_tr_b16 v[48:49], v33 offset:16384
    ds_read_b64_tr_b16 v[50:51], v33 offset:17408
    v_mfma_f32_32x32x16_bf16 v[72:87], v[60:63], v[52:55], v[72:87]
    v_mfma_f32_32x32x16_bf16 v[88:103], v[60:63], v[56:59], v[88:103]
    v_mfma_f32_32x32x16_bf16 v[104:119], v[64:67], v[52:55], v[104:119]
    v_mfma_f32_32x32x16_bf16 v[120:135], v[64:67], v[56:59], v[120:135]
    ds_read_b128 v[52:55], v25 offset:0
    ds_read_b128 v[56:59], v25 offset:4096
    ds_read_b64_tr_b16 v[60:61], v33 offset:4096
    ds_read_b64_tr_b16 v[62:63], v33 offset:5120
    ds_read_b64_tr_b16 v[64:65], v33 offset:20480
    ds_read_b64_tr_b16 v[66:67], v33 offset:21504
    s_waitcnt lgkmcnt(6)
    v_mfma_f32_32x32x16_bf16 v[72:87], v[44:47], v[36:39], v[72:87]
    v_mfma_f32_32x32x16_bf16 v[88:103], v[44:47], v[40:43], v[88:103]
    v_mfma_f32_32x32x16_bf16 v[104:119], v[48:51], v[36:39], v[104:119]
    v_mfma_f32_32x32x16_bf16 v[120:135], v[48:51], v[40:43], v[120:135]
    ds_read_b128 v[36:39], v26 offset:0
    ds_read_b128 v[40:43], v26 offset:4096
    ds_read_b64_tr_b16 v[44:45], v33 offset:8192
    ds_read_b64_tr_b16 v[46:47], v33 offset:9216
    ds_read_b64_tr_b16 v[48:49], v33 offset:24576
    ds_read_b64_tr_b16 v[50:51], v33 offset:25600
    s_waitcnt lgkmcnt(6)
    v_mfma_f32_32x32x16_bf16 v[72:87], v[60:63], v[52:55], v[72:87]
    v_mfma_f32_32x32x16_bf16 v[88:103], v[60:63], v[56:59], v[88:103]
    v_mfma_f32_32x32x16_bf16 v[104:119], v[64:67], v[52:55], v[104:119]
    v_mfma_f32_32x32x16_bf16 v[120:135], v[64:67], v[56:59], v[120:135]
    ds_read_b128 v[52:55], v27 offset:0
    ds_read_b128 v[56:59], v27 offset:4096
    ds_read_b64_tr_b16 v[60:61], v33 offset:12288
    ds_read_b64_tr_b16 v[62:63], v33 offset:13312
    ds_read_b64_tr_b16 v[64:65], v33 offset:28672
    ds_read_b64_tr_b16 v[66:67], v33 offset:29696
    s_waitcnt lgkmcnt(6)
    v_mfma_f32_32x32x16_bf16 v[72:87], v[44:47], v[36:39], v[72:87]
    v_mfma_f32_32x32x16_bf16 v[88:103], v[44:47], v[40:43], v[88:103]
    v_mfma_f32_32x32x16_bf16 v[104:119], v[48:51], v[36:39], v[104:119]
    v_mfma_f32_32x32x16_bf16 v[120:135], v[48:51], v[40:43], v[120:135]
    v_add_u32 v24, s47, v16
    v_add_u32 v25, s47, v17
    v_add_u32 v26, s47, v18
    v_add_u32 v27, s47, v19
    v_add_u32 v33, s47, v32
    s_add_u32 s47, s47, 49152
    s_cmp_ge_u32 s47, 147456
    s_cselect_b32 s47, 0, s47
    s_waitcnt vmcnt(0) lgkmcnt(0)
    s_barrier
    ds_read_b128 v[36:39], v24 offset:0
    ds_read_b128 v[40:43], v24 offset:4096
    ds_read_b64_tr_b16 v[44:45], v33 offset:0
    ds_read_b64_tr_b16 v[46:47], v33 offset:1024
    ds_read_b64_tr_b16 v[48:49], v33 offset:16384
    ds_read_b64_tr_b16 v[50:51], v33 offset:17408
    v_mfma_f32_32x32x16_bf16 v[72:87], v[60:63], v[52:55], v[72:87]
    v_mfma_f32_32x32x16_bf16 v[88:103], v[60:63], v[56:59], v[88:103]
    v_mfma_f32_32x32x16_bf16 v[104:119], v[64:67], v[52:55], v[104:119]
    v_mfma_f32_32x32x16_bf16 v[120:135], v[64:67], v[56:59], v[120:135]
    ds_read_b128 v[52:55], v25 offset:0
    ds_read_b128 v[56:59], v25 offset:4096
    ds_read_b64_tr_b16 v[60:61], v33 offset:4096
    ds_read_b64_tr_b16 v[62:63], v33 offset:5120
    ds_read_b64_tr_b16 v[64:65], v33 offset:20480
    ds_read_b64_tr_b16 v[66:67], v33 offset:21504
    s_waitcnt lgkmcnt(6)
    v_mfma_f32_32x32x16_bf16 v[72:87], v[44:47], v[36:39], v[72:87]
    v_mfma_f32_32x32x16_bf16 v[88:103], v[44:47], v[40:43], v[88:103]
    v_mfma_f32_32x32x16_bf16 v[104:119], v[48:51], v[36:39], v[104:119]
    v_mfma_f32_32x32x16_bf16 v[120:135], v[48:51], v[40:43], v[120:135]
    ds_read_b128 v[36:39], v26 offset:0
    ds_read_b128 v[40:43], v26 offset:4096
    ds_read_b64_tr_b16 v[44:45], v33 offset:8192
    ds_read_b64_tr_b16 v[46:47], v33 offset:9216
    ds_read_b64_tr_b16 v[48:49], v33 offset:24576
    ds_read_b64_tr_b16 v[50:51], v33 offset:25600
    s_waitcnt lgkmcnt(6)
    v_mfma_f32_32x32x16_bf16 v[72:87], v[60:63], v[52:55], v[72:87]
    v_mfma_f32_32x32x16_bf16 v[88:103], v[60:63], v[56:59], v[88:103]
    v_mfma_f32_32x32x16_bf16 v[104:119], v[64:67], v[52:55], v[104:119]
    v_mfma_f32_32x32x16_bf16 v[120:135], v[64:67], v[56:59], v[120:135]
    ds_read_b128 v[52:55], v27 offset:0
    ds_read_b128 v[56:59], v27 offset:4096
    ds_read_b64_tr_b16 v[60:61], v33 offset:12288
    ds_read_b64_tr_b16 v[62:63], v33 offset:13312
    ds_read_b64_tr_b16 v[64:65], v33 offset:28672
    ds_read_b64_tr_b16 v[66:67], v33 offset:29696
    s_waitcnt lgkmcnt(6)
    v_mfma_f32_32x32x16_bf16 v[72:87], v[44:47], v[36:39], v[72:87]
    v_mfma_f32_32x32x16_bf16 v[88:103], v[44:47], v[40:43], v[88:103]
    v_mfma_f32_32x32x16_bf16 v[104:119], v[48:51], v[36:39], v[104:119]
    v_mfma_f32_32x32x16_bf16 v[120:135], v[48:51], v[40:43], v[120:135]
    s_waitcnt lgkmcnt(0)
    v_mfma_f32_32x32x16_bf16 v[72:87], v[60:63], v[52:55], v[72:87]
    v_mfma_f32_32x32x16_bf16 v[88:103], v[60:63], v[56:59], v[88:103]
    v_mfma_f32_32x32x16_bf16 v[104:119], v[64:67], v[52:55], v[104:119]
    v_mfma_f32_32x32x16_bf16 v[120:135], v[64:67], v[56:59], v[120:135]
    s_nop 15
    s_lshl_b32 s25, s23, 6
    v_add_u32 v10, s25, v5
    s_movk_i32 s25, 272
    v_mul_lo_u32 v10, v10, s25
    v_lshl_add_u32 v10, v7, 3, v10
    s_lshl_b32 s25, s24, 6
    s_add_u32 s25, s25, 98304
    v_add_u32 v10, s25, v10
    v_mul_f32 v36, v72, v72
    v_mul_f32 v37, v73, v73
    v_mul_f32 v38, v74, v74
    v_mul_f32 v39, v75, v75
    v_mul_f32 v40, v76, v76
    v_mul_f32 v41, v77, v77
    v_mul_f32 v42, v78, v78
    v_mul_f32 v43, v79, v79
    v_mul_f32 v104, v104, v72
    v_mul_f32 v105, v105, v73
    v_mul_f32 v106, v106, v74
    v_mul_f32 v107, v107, v75
    v_mul_f32 v108, v108, v76
    v_mul_f32 v109, v109, v77
    v_mul_f32 v110, v110, v78
    v_mul_f32 v111, v111, v79
    v_fma_f32 v36, v36, v185, v184
    v_fma_f32 v37, v37, v185, v184
    v_fma_f32 v38, v38, v185, v184
    v_fma_f32 v39, v39, v185, v184
    v_fma_f32 v40, v40, v185, v184
    v_fma_f32 v41, v41, v185, v184
    v_fma_f32 v42, v42, v185, v184
    v_fma_f32 v43, v43, v185, v184
    v_mul_f32 v36, v36, v72
    v_mul_f32 v37, v37, v73
    v_mul_f32 v38, v38, v74
    v_mul_f32 v39, v39, v75
    v_mul_f32 v40, v40, v76
    v_mul_f32 v41, v41, v77
    v_mul_f32 v42, v42, v78
    v_mul_f32 v43, v43, v79
    v_exp_f32 v36, v36
    v_exp_f32 v37, v37
    v_exp_f32 v38, v38
    v_exp_f32 v39, v39
    v_exp_f32 v40, v40
    v_exp_f32 v41, v41
    v_exp_f32 v42, v42
    v_exp_f32 v43, v43
    v_fma_f32 v36, v36, v186, v186
    v_fma_f32 v37, v37, v186, v186
    v_fma_f32 v38, v38, v186, v186
    v_fma_f32 v39, v39, v186, v186
    v_fma_f32 v40, v40, v186, v186
    v_fma_f32 v41, v41, v186, v186
    v_fma_f32 v42, v42, v186, v186
    v_fma_f32 v43, v43, v186, v186
    v_rcp_f32 v36, v36
    v_rcp_f32 v37, v37
    v_rcp_f32 v38, v38
    v_rcp_f32 v39, v39
    v_rcp_f32 v40, v40
    v_rcp_f32 v41, v41
    v_rcp_f32 v42, v42
    v_rcp_f32 v43, v43
    v_mul_f32 v104, v104, v36
    v_mul_f32 v105, v105, v37
    v_mul_f32 v106, v106, v38
    v_mul_f32 v107, v107, v39
    v_mul_f32 v108, v108, v40
    v_mul_f32 v109, v109, v41
    v_mul_f32 v110, v110, v42
    v_mul_f32 v111, v111, v43
    v_mul_f32 v36, v80, v80
    v_mul_f32 v37, v81, v81
    v_mul_f32 v38, v82, v82
    v_mul_f32 v39, v83, v83
    v_mul_f32 v40, v84, v84
    v_mul_f32 v41, v85, v85
    v_mul_f32 v42, v86, v86
    v_mul_f32 v43, v87, v87
    v_mul_f32 v112, v112, v80
    v_mul_f32 v113, v113, v81
    v_mul_f32 v114, v114, v82
    v_mul_f32 v115, v115, v83
    v_mul_f32 v116, v116, v84
    v_mul_f32 v117, v117, v85
    v_mul_f32 v118, v118, v86
    v_mul_f32 v119, v119, v87
    v_fma_f32 v36, v36, v185, v184
    v_fma_f32 v37, v37, v185, v184
    v_fma_f32 v38, v38, v185, v184
    v_fma_f32 v39, v39, v185, v184
    v_fma_f32 v40, v40, v185, v184
    v_fma_f32 v41, v41, v185, v184
    v_fma_f32 v42, v42, v185, v184
    v_fma_f32 v43, v43, v185, v184
    v_mul_f32 v36, v36, v80
    v_mul_f32 v37, v37, v81
    v_mul_f32 v38, v38, v82
    v_mul_f32 v39, v39, v83
    v_mul_f32 v40, v40, v84
    v_mul_f32 v41, v41, v85
    v_mul_f32 v42, v42, v86
    v_mul_f32 v43, v43, v87
    v_exp_f32 v36, v36
    v_exp_f32 v37, v37
    v_exp_f32 v38, v38
    v_exp_f32 v39, v39
    v_exp_f32 v40, v40
    v_exp_f32 v41, v41
    v_exp_f32 v42, v42
    v_exp_f32 v43, v43
    v_fma_f32 v36, v36, v186, v186
    v_fma_f32 v37, v37, v186, v186
    v_fma_f32 v38, v38, v186, v186
    v_fma_f32 v39, v39, v186, v186
    v_fma_f32 v40, v40, v186, v186
    v_fma_f32 v41, v41, v186, v186
    v_fma_f32 v42, v42, v186, v186
    v_fma_f32 v43, v43, v186, v186
    v_rcp_f32 v36, v36
    v_rcp_f32 v37, v37
    v_rcp_f32 v38, v38
    v_rcp_f32 v39, v39
    v_rcp_f32 v40, v40
    v_rcp_f32 v41, v41
    v_rcp_f32 v42, v42
    v_rcp_f32 v43, v43
    v_mul_f32 v112, v112, v36
    v_mul_f32 v113, v113, v37
    v_mul_f32 v114, v114, v38
    v_mul_f32 v115, v115, v39
    v_mul_f32 v116, v116, v40
    v_mul_f32 v117, v117, v41
    v_mul_f32 v118, v118, v42
    v_mul_f32 v119, v119, v43
    v_cvt_pk_bf16_f32 v104, v104, v105
    v_cvt_pk_bf16_f32 v105, v106, v107
    v_cvt_pk_bf16_f32 v106, v108, v109
    v_cvt_pk_bf16_f32 v107, v110, v111
    v_cvt_pk_bf16_f32 v108, v112, v113
    v_cvt_pk_bf16_f32 v109, v114, v115
    v_cvt_pk_bf16_f32 v110, v116, v117
    v_cvt_pk_bf16_f32 v111, v118, v119
    ds_write_b64 v10, v[104:105] offset:0
    ds_write_b64 v10, v[106:107] offset:16
    ds_write_b64 v10, v[108:109] offset:32
    ds_write_b64 v10, v[110:111] offset:48
    v_mul_f32 v36, v88, v88
    v_mul_f32 v37, v89, v89
    v_mul_f32 v38, v90, v90
    v_mul_f32 v39, v91, v91
    v_mul_f32 v40, v92, v92
    v_mul_f32 v41, v93, v93
    v_mul_f32 v42, v94, v94
    v_mul_f32 v43, v95, v95
    v_mul_f32 v120, v120, v88
    v_mul_f32 v121, v121, v89
    v_mul_f32 v122, v122, v90
    v_mul_f32 v123, v123, v91
    v_mul_f32 v124, v124, v92
    v_mul_f32 v125, v125, v93
    v_mul_f32 v126, v126, v94
    v_mul_f32 v127, v127, v95
    v_fma_f32 v36, v36, v189, v188
    v_fma_f32 v37, v37, v189, v188
    v_fma_f32 v38, v38, v189, v188
    v_fma_f32 v39, v39, v189, v188
    v_fma_f32 v40, v40, v189, v188
    v_fma_f32 v41, v41, v189, v188
    v_fma_f32 v42, v42, v189, v188
    v_fma_f32 v43, v43, v189, v188
    v_mul_f32 v36, v36, v88
    v_mul_f32 v37, v37, v89
    v_mul_f32 v38, v38, v90
    v_mul_f32 v39, v39, v91
    v_mul_f32 v40, v40, v92
    v_mul_f32 v41, v41, v93
    v_mul_f32 v42, v42, v94
    v_mul_f32 v43, v43, v95
    v_exp_f32 v36, v36
    v_exp_f32 v37, v37
    v_exp_f32 v38, v38
    v_exp_f32 v39, v39
    v_exp_f32 v40, v40
    v_exp_f32 v41, v41
    v_exp_f32 v42, v42
    v_exp_f32 v43, v43
    v_fma_f32 v36, v36, v190, v190
    v_fma_f32 v37, v37, v190, v190
    v_fma_f32 v38, v38, v190, v190
    v_fma_f32 v39, v39, v190, v190
    v_fma_f32 v40, v40, v190, v190
    v_fma_f32 v41, v41, v190, v190
    v_fma_f32 v42, v42, v190, v190
    v_fma_f32 v43, v43, v190, v190
    v_rcp_f32 v36, v36
    v_rcp_f32 v37, v37
    v_rcp_f32 v38, v38
    v_rcp_f32 v39, v39
    v_rcp_f32 v40, v40
    v_rcp_f32 v41, v41
    v_rcp_f32 v42, v42
    v_rcp_f32 v43, v43
    v_mul_f32 v120, v120, v36
    v_mul_f32 v121, v121, v37
    v_mul_f32 v122, v122, v38
    v_mul_f32 v123, v123, v39
    v_mul_f32 v124, v124, v40
    v_mul_f32 v125, v125, v41
    v_mul_f32 v126, v126, v42
    v_mul_f32 v127, v127, v43
    v_mul_f32 v36, v96, v96
    v_mul_f32 v37, v97, v97
    v_mul_f32 v38, v98, v98
    v_mul_f32 v39, v99, v99
    v_mul_f32 v40, v100, v100
    v_mul_f32 v41, v101, v101
    v_mul_f32 v42, v102, v102
    v_mul_f32 v43, v103, v103
    v_mul_f32 v128, v128, v96
    v_mul_f32 v129, v129, v97
    v_mul_f32 v130, v130, v98
    v_mul_f32 v131, v131, v99
    v_mul_f32 v132, v132, v100
    v_mul_f32 v133, v133, v101
    v_mul_f32 v134, v134, v102
    v_mul_f32 v135, v135, v103
    v_fma_f32 v36, v36, v189, v188
    v_fma_f32 v37, v37, v189, v188
    v_fma_f32 v38, v38, v189, v188
    v_fma_f32 v39, v39, v189, v188
    v_fma_f32 v40, v40, v189, v188
    v_fma_f32 v41, v41, v189, v188
    v_fma_f32 v42, v42, v189, v188
    v_fma_f32 v43, v43, v189, v188
    v_mul_f32 v36, v36, v96
    v_mul_f32 v37, v37, v97
    v_mul_f32 v38, v38, v98
    v_mul_f32 v39, v39, v99
    v_mul_f32 v40, v40, v100
    v_mul_f32 v41, v41, v101
    v_mul_f32 v42, v42, v102
    v_mul_f32 v43, v43, v103
    v_exp_f32 v36, v36
    v_exp_f32 v37, v37
    v_exp_f32 v38, v38
    v_exp_f32 v39, v39
    v_exp_f32 v40, v40
    v_exp_f32 v41, v41
    v_exp_f32 v42, v42
    v_exp_f32 v43, v43
    v_fma_f32 v36, v36, v190, v190
    v_fma_f32 v37, v37, v190, v190
    v_fma_f32 v38, v38, v190, v190
    v_fma_f32 v39, v39, v190, v190
    v_fma_f32 v40, v40, v190, v190
    v_fma_f32 v41, v41, v190, v190
    v_fma_f32 v42, v42, v190, v190
    v_fma_f32 v43, v43, v190, v190
    v_rcp_f32 v36, v36
    v_rcp_f32 v37, v37
    v_rcp_f32 v38, v38
    v_rcp_f32 v39, v39
    v_rcp_f32 v40, v40
    v_rcp_f32 v41, v41
    v_rcp_f32 v42, v42
    v_rcp_f32 v43, v43
    v_mul_f32 v128, v128, v36
    v_mul_f32 v129, v129, v37
    v_mul_f32 v130, v130, v38
    v_mul_f32 v131, v131, v39
    v_mul_f32 v132, v132, v40
    v_mul_f32 v133, v133, v41
    v_mul_f32 v134, v134, v42
    v_mul_f32 v135, v135, v43
    v_cvt_pk_bf16_f32 v120, v120, v121
    v_cvt_pk_bf16_f32 v121, v122, v123
    v_cvt_pk_bf16_f32 v122, v124, v125
    v_cvt_pk_bf16_f32 v123, v126, v127
    v_cvt_pk_bf16_f32 v124, v128, v129
    v_cvt_pk_bf16_f32 v125, v130, v131
    v_cvt_pk_bf16_f32 v126, v132, v133
    v_cvt_pk_bf16_f32 v127, v134, v135
    ds_write_b64 v10, v[120:121] offset:8704
    ds_write_b64 v10, v[122:123] offset:8720
    ds_write_b64 v10, v[124:125] offset:8736
    ds_write_b64 v10, v[126:127] offset:8752
    v_lshrrev_b32 v3, 4, v0
    v_and_b32 v6, 15, v0
    s_movk_i32 s25, 272
    v_mul_lo_u32 v10, v3, s25
    v_lshl_add_u32 v10, v6, 4, v10
    v_add_u32 v10, 98304, v10
    s_movk_i32 s25, 3584
    v_mul_lo_u32 v3, v3, s25
    v_lshl_add_u32 v3, v6, 4, v3
    s_mul_i32 s31, s21, 3584
    s_lshl_b32 s25, s22, 1
    s_add_u32 s31, s31, s25
    s_add_u32 s31, s31, 8388608
    s_waitcnt lgkmcnt(0)
    s_barrier
    ds_read_b128 v[72:75], v10 offset:0
    ds_read_b128 v[76:79], v10 offset:8704
    ds_read_b128 v[80:83], v10 offset:17408
    ds_read_b128 v[84:87], v10 offset:26112
    s_waitcnt lgkmcnt(3)
    buffer_store_dwordx4 v[72:75], v3, s[16:19], s31 offen
    s_add_u32 s31, s31, 114688
    s_waitcnt lgkmcnt(2)
    buffer_store_dwordx4 v[76:79], v3, s[16:19], s31 offen
    s_add_u32 s31, s31, 114688
    s_waitcnt lgkmcnt(1)
    buffer_store_dwordx4 v[80:83], v3, s[16:19], s31 offen
    s_add_u32 s31, s31, 114688
    s_waitcnt lgkmcnt(0)
    buffer_store_dwordx4 v[84:87], v3, s[16:19], s31 offen
L_ffn_kernel_end:
    s_endpgm
.globl down_kernel
.p2align 8
.type down_kernel,@function
down_kernel:
    s_cmp_ge_u32 s2, 256
    s_cbranch_scc1 L_down_kernel_end
    s_load_dwordx4 s[4:7], s[0:1], 64
    s_load_dwordx2 s[36:37], s[0:1], 88
    v_and_b32 v4, 63, v0
    v_lshrrev_b32 v6, 6, v0
    v_and_b32 v5, 31, v0
    v_readfirstlane_b32 s20, v6
    v_bfe_u32 v7, v0, 5, 1
    s_and_b32 s21, s2, 7
    s_lshl_b32 s21, s21, 2
    s_lshr_b32 s22, s2, 6
    s_add_u32 s21, s21, s22
    s_lshl_b32 s21, s21, 6
    s_bfe_u32 s22, s2, 0x30003
    s_lshl_b32 s22, s22, 6
    s_waitcnt lgkmcnt(0)
    s_mov_b32 s12, s4
    s_mov_b32 s13, s5
    s_mov_b32 s14, 1835008
    s_mov_b32 s15, 0x00020000
    s_mov_b32 s8, s6
    s_mov_b32 s9, s7
    s_mov_b32 s10, 2097152
    s_mov_b32 s11, 0x00020000
    s_mov_b32 s16, s36
    s_mov_b32 s17, s37
    s_mov_b32 s18, 268435456
    s_mov_b32 s19, 0x00020000
    s_lshl_b32 s31, s21, 10
    s_lshl_b32 s25, s22, 1
    s_add_u32 s31, s31, s25
    v_lshrrev_b32 v3, 3, v0
    v_and_b32 v6, 7, v0
    v_lshlrev_b32 v3, 10, v3
    v_lshl_add_u32 v3, v6, 4, v3
    s_add_u32 s25, s31, 5242880
    buffer_load_dwordx4 v[80:83], v3, s[16:19], s25 offen
    s_add_u32 s25, s31, 5275648
    buffer_load_dwordx4 v[84:87], v3, s[16:19], s25 offen
    s_and_b32 s23, s20, 1
    s_lshr_b32 s24, s20, 1
    v_lshrrev_b32 v10, 4, v4
    v_and_b32 v11, 15, v4
    v_lshrrev_b32 v12, 4, v4
    s_lshl_b32 s25, s20, 2
    v_add_u32 v12, s25, v12
    v_and_b32 v12, 15, v12
    v_xor_b32 v11, v11, v12
    s_mov_b32 s25, 3584
    v_mul_lo_u32 v10, v10, s25
    v_lshl_add_u32 v1, v11, 4, v10
    v_lshrrev_b32 v10, 3, v4
    v_and_b32 v11, 7, v4
    v_bfe_u32 v12, v4, 4, 1
    v_lshlrev_b32 v12, 2, v12
    v_xor_b32 v11, v11, v12
    s_mov_b32 s25, 1024
    v_mul_lo_u32 v10, v10, s25
    v_lshl_add_u32 v2, v11, 4, v10
    s_mul_i32 s25, s20, 4
    s_add_u32 s25, s25, s21
    s_mul_i32 s26, s25, 3584
    s_add_u32 s26, s26, 8388608
    s_mul_i32 s27, s20, 8192
    s_lshl_b32 s25, s22, 1
    s_add_u32 s27, s27, s25
    s_lshl_b32 s28, s20, 10
    s_mov_b32 s29, s28
    s_add_u32 s30, s28, 131072
    s_mov_b32 s46, 3
L_down_kernel_pre:
    s_add_u32 s38, s29, 0
    s_mov_b32 m0, s38
    s_add_u32 s39, s26, 0
    buffer_load_dwordx4 v1, s[16:19], s39 offen lds
    s_add_u32 s38, s29, 4096
    s_mov_b32 m0, s38
    s_add_u32 s39, s26, 57344
    buffer_load_dwordx4 v1, s[16:19], s39 offen lds
    s_add_u32 s38, s29, 8192
    s_mov_b32 m0, s38
    s_add_u32 s39, s26, 114688
    buffer_load_dwordx4 v1, s[16:19], s39 offen lds
    s_add_u32 s38, s29, 12288
    s_mov_b32 m0, s38
    s_add_u32 s39, s26, 172032
    buffer_load_dwordx4 v1, s[16:19], s39 offen lds
    s_add_u32 s38, s29, 16384
    s_mov_b32 m0, s38
    s_add_u32 s39, s27, 0
    buffer_load_dwordx4 v2, s[12:15], s39 offen lds
    s_add_u32 s38, s29, 20480
    s_mov_b32 m0, s38
    s_add_u32 s39, s27, 32768
    buffer_load_dwordx4 v2, s[12:15], s39 offen lds
    s_add_u32 s38, s29, 24576
    s_mov_b32 m0, s38
    s_add_u32 s39, s27, 65536
    buffer_load_dwordx4 v2, s[12:15], s39 offen lds
    s_add_u32 s38, s29, 28672
    s_mov_b32 m0, s38
    s_add_u32 s39, s27, 98304
    buffer_load_dwordx4 v2, s[12:15], s39 offen lds
    s_add_u32 s26, s26, 256
    s_add_u32 s27, s27, 131072
    s_add_u32 s29, s29, 32768
    s_cmp_ge_u32 s29, s30
    s_cselect_b32 s29, s28, s29
    s_sub_u32 s46, s46, 1
    s_cmp_lg_u32 s46, 0
    s_cbranch_scc1 L_down_kernel_pre
    v_and_b32 v10, 15, v5
    v_xor_b32 v10, v10, v7
    v_lshlrev_b32 v10, 4, v10
    v_lshl_add_u32 v10, v5, 8, v10
    s_mul_i32 s25, s23, 8192
    v_xor_b32 v16, 0, v10
    v_add_u32 v16, s25, v16
    v_xor_b32 v17, 32, v10
    v_add_u32 v17, s25, v17
    v_xor_b32 v18, 64, v10
    v_add_u32 v18, s25, v18
    v_xor_b32 v19, 96, v10
    v_add_u32 v19, s25, v19
    v_xor_b32 v20, 128, v10
    v_add_u32 v20, s25, v20
    v_xor_b32 v21, 160, v10
    v_add_u32 v21, s25, v21
    v_xor_b32 v22, 192, v10
    v_add_u32 v22, s25, v22
    v_xor_b32 v23, 224, v10
    v_add_u32 v23, s25, v23
    v_bfe_u32 v10, v0, 2, 2
    v_lshl_add_u32 v11, v7, 3, v10
    v_lshlrev_b32 v11, 7, v11
    v_bfe_u32 v12, v0, 4, 1
    v_bfe_u32 v13, v0, 1, 1
    v_lshl_add_u32 v12, v12, 1, v13
    v_bfe_u32 v13, v0, 3, 1
    v_lshlrev_b32 v13, 2, v13
    v_xor_b32 v12, v12, v13
    v_lshl_add_u32 v11, v12, 4, v11
    v_and_b32 v13, 1, v0
    v_lshl_add_u32 v14, v13, 3, v11
    s_mul_i32 s25, s24, 1
    s_add_u32 s25, s25, 0
    s_lshl_b32 s25, s25, 6
    v_xor_b32 v32, s25, v14
    v_add_u32 v32, 16384, v32
    v_mov_b32 v64, 0
    v_mov_b32 v65, 0
    v_mov_b32 v66, 0
    v_mov_b32 v67, 0
    v_mov_b32 v68, 0
    v_mov_b32 v69, 0
    v_mov_b32 v70, 0
    v_mov_b32 v71, 0
    v_mov_b32 v72, 0
    v_mov_b32 v73, 0
    v_mov_b32 v74, 0
    v_mov_b32 v75, 0
    v_mov_b32 v76, 0
    v_mov_b32 v77, 0
    v_mov_b32 v78, 0
    v_mov_b32 v79, 0
    v_mov_b32 v44, 0
    v_mov_b32 v45, 0
    v_mov_b32 v46, 0
    v_mov_b32 v47, 0
    v_mov_b32 v48, 0
    v_mov_b32 v49, 0
    v_mov_b32 v50, 0
    v_mov_b32 v51, 0
    s_mov_b32 s47, 0
    s_mov_b32 s46, 11
L_down_kernel_main:
    v_add_u32 v24, s47, v16
    v_add_u32 v25, s47, v17
    v_add_u32 v26, s47, v18
    v_add_u32 v27, s47, v19
    v_add_u32 v28, s47, v20
    v_add_u32 v29, s47, v21
    v_add_u32 v30, s47, v22
    v_add_u32 v31, s47, v23
    v_add_u32 v33, s47, v32
    s_add_u32 s47, s47, 32768
    s_cmp_ge_u32 s47, 131072
    s_cselect_b32 s47, 0, s47
    s_waitcnt vmcnt(16) lgkmcnt(0)
    s_barrier
    ds_read_b128 v[36:39], v24 offset:0
    ds_read_b64_tr_b16 v[40:41], v33 offset:0
    ds_read_b64_tr_b16 v[42:43], v33 offset:512
    v_mfma_f32_32x32x16_bf16 v[64:79], v[48:51], v[44:47], v[64:79]
    s_add_u32 s38, s29, 0
    s_mov_b32 m0, s38
    s_add_u32 s39, s26, 0
    buffer_load_dwordx4 v1, s[16:19], s39 offen lds
    ds_read_b128 v[44:47], v25 offset:0
    ds_read_b64_tr_b16 v[48:49], v33 offset:2048
    ds_read_b64_tr_b16 v[50:51], v33 offset:2560
    s_waitcnt lgkmcnt(3)
    v_mfma_f32_32x32x16_bf16 v[64:79], v[40:43], v[36:39], v[64:79]
    s_add_u32 s38, s29, 4096
    s_mov_b32 m0, s38
    s_add_u32 s39, s26, 57344
    buffer_load_dwordx4 v1, s[16:19], s39 offen lds
    ds_read_b128 v[36:39], v26 offset:0
    ds_read_b64_tr_b16 v[40:41], v33 offset:4096
    ds_read_b64_tr_b16 v[42:43], v33 offset:4608
    s_waitcnt lgkmcnt(3)
    v_mfma_f32_32x32x16_bf16 v[64:79], v[48:51], v[44:47], v[64:79]
    s_add_u32 s38, s29, 8192
    s_mov_b32 m0, s38
    s_add_u32 s39, s26, 114688
    buffer_load_dwordx4 v1, s[16:19], s39 offen lds
    ds_read_b128 v[44:47], v27 offset:0
    ds_read_b64_tr_b16 v[48:49], v33 offset:6144
    ds_read_b64_tr_b16 v[50:51], v33 offset:6656
    s_waitcnt lgkmcnt(3)
    v_mfma_f32_32x32x16_bf16 v[64:79], v[40:43], v[36:39], v[64:79]
    s_add_u32 s38, s29, 12288
    s_mov_b32 m0, s38
    s_add_u32 s39, s26, 172032
    buffer_load_dwordx4 v1, s[16:19], s39 offen lds
    ds_read_b128 v[36:39], v28 offset:0
    ds_read_b64_tr_b16 v[40:41], v33 offset:8192
    ds_read_b64_tr_b16 v[42:43], v33 offset:8704
    s_waitcnt lgkmcnt(3)
    v_mfma_f32_32x32x16_bf16 v[64:79], v[48:51], v[44:47], v[64:79]
    s_add_u32 s38, s29, 16384
    s_mov_b32 m0, s38
    s_add_u32 s39, s27, 0
    buffer_load_dwordx4 v2, s[12:15], s39 offen lds
    ds_read_b128 v[44:47], v29 offset:0
    ds_read_b64_tr_b16 v[48:49], v33 offset:10240
    ds_read_b64_tr_b16 v[50:51], v33 offset:10752
    s_waitcnt lgkmcnt(3)
    v_mfma_f32_32x32x16_bf16 v[64:79], v[40:43], v[36:39], v[64:79]
    s_add_u32 s38, s29, 20480
    s_mov_b32 m0, s38
    s_add_u32 s39, s27, 32768
    buffer_load_dwordx4 v2, s[12:15], s39 offen lds
    ds_read_b128 v[36:39], v30 offset:0
    ds_read_b64_tr_b16 v[40:41], v33 offset:12288
    ds_read_b64_tr_b16 v[42:43], v33 offset:12800
    s_waitcnt lgkmcnt(3)
    v_mfma_f32_32x32x16_bf16 v[64:79], v[48:51], v[44:47], v[64:79]
    s_add_u32 s38, s29, 24576
    s_mov_b32 m0, s38
    s_add_u32 s39, s27, 65536
    buffer_load_dwordx4 v2, s[12:15], s39 offen lds
    ds_read_b128 v[44:47], v31 offset:0
    ds_read_b64_tr_b16 v[48:49], v33 offset:14336
    ds_read_b64_tr_b16 v[50:51], v33 offset:14848
    s_waitcnt lgkmcnt(3)
    v_mfma_f32_32x32x16_bf16 v[64:79], v[40:43], v[36:39], v[64:79]
    s_add_u32 s38, s29, 28672
    s_mov_b32 m0, s38
    s_add_u32 s39, s27, 98304
    buffer_load_dwordx4 v2, s[12:15], s39 offen lds
    s_add_u32 s26, s26, 256
    s_add_u32 s27, s27, 131072
    s_add_u32 s29, s29, 32768
    s_cmp_ge_u32 s29, s30
    s_cselect_b32 s29, s28, s29
    s_sub_u32 s46, s46, 1
    s_cmp_lg_u32 s46, 0
    s_cbranch_scc1 L_down_kernel_main
    v_add_u32 v24, s47, v16
    v_add_u32 v25, s47, v17
    v_add_u32 v26, s47, v18
    v_add_u32 v27, s47, v19
    v_add_u32 v28, s47, v20
    v_add_u32 v29, s47, v21
    v_add_u32 v30, s47, v22
    v_add_u32 v31, s47, v23
    v_add_u32 v33, s47, v32
    s_add_u32 s47, s47, 32768
    s_cmp_ge_u32 s47, 131072
    s_cselect_b32 s47, 0, s47
    s_waitcnt vmcnt(16) lgkmcnt(0)
    s_barrier
    ds_read_b128 v[36:39], v24 offset:0
    ds_read_b64_tr_b16 v[40:41], v33 offset:0
    ds_read_b64_tr_b16 v[42:43], v33 offset:512
    v_mfma_f32_32x32x16_bf16 v[64:79], v[48:51], v[44:47], v[64:79]
    ds_read_b128 v[44:47], v25 offset:0
    ds_read_b64_tr_b16 v[48:49], v33 offset:2048
    ds_read_b64_tr_b16 v[50:51], v33 offset:2560
    s_waitcnt lgkmcnt(3)
    v_mfma_f32_32x32x16_bf16 v[64:79], v[40:43], v[36:39], v[64:79]
    ds_read_b128 v[36:39], v26 offset:0
    ds_read_b64_tr_b16 v[40:41], v33 offset:4096
    ds_read_b64_tr_b16 v[42:43], v33 offset:4608
    s_waitcnt lgkmcnt(3)
    v_mfma_f32_32x32x16_bf16 v[64:79], v[48:51], v[44:47], v[64:79]
    ds_read_b128 v[44:47], v27 offset:0
    ds_read_b64_tr_b16 v[48:49], v33 offset:6144
    ds_read_b64_tr_b16 v[50:51], v33 offset:6656
    s_waitcnt lgkmcnt(3)
    v_mfma_f32_32x32x16_bf16 v[64:79], v[40:43], v[36:39], v[64:79]
    ds_read_b128 v[36:39], v28 offset:0
    ds_read_b64_tr_b16 v[40:41], v33 offset:8192
    ds_read_b64_tr_b16 v[42:43], v33 offset:8704
    s_waitcnt lgkmcnt(3)
    v_mfma_f32_32x32x16_bf16 v[64:79], v[48:51], v[44:47], v[64:79]
    ds_read_b128 v[44:47], v29 offset:0
    ds_read_b64_tr_b16 v[48:49], v33 offset:10240
    ds_read_b64_tr_b16 v[50:51], v33 offset:10752
    s_waitcnt lgkmcnt(3)
    v_mfma_f32_32x32x16_bf16 v[64:79], v[40:43], v[36:39], v[64:79]
    ds_read_b128 v[36:39], v30 offset:0
    ds_read_b64_tr_b16 v[40:41], v33 offset:12288
    ds_read_b64_tr_b16 v[42:43], v33 offset:12800
    s_waitcnt lgkmcnt(3)
    v_mfma_f32_32x32x16_bf16 v[64:79], v[48:51], v[44:47], v[64:79]
    ds_read_b128 v[44:47], v31 offset:0
    ds_read_b64_tr_b16 v[48:49], v33 offset:14336
    ds_read_b64_tr_b16 v[50:51], v33 offset:14848
    s_waitcnt lgkmcnt(3)
    v_mfma_f32_32x32x16_bf16 v[64:79], v[40:43], v[36:39], v[64:79]
    v_add_u32 v24, s47, v16
    v_add_u32 v25, s47, v17
    v_add_u32 v26, s47, v18
    v_add_u32 v27, s47, v19
    v_add_u32 v28, s47, v20
    v_add_u32 v29, s47, v21
    v_add_u32 v30, s47, v22
    v_add_u32 v31, s47, v23
    v_add_u32 v33, s47, v32
    s_add_u32 s47, s47, 32768
    s_cmp_ge_u32 s47, 131072
    s_cselect_b32 s47, 0, s47
    s_waitcnt vmcnt(8) lgkmcnt(0)
    s_barrier
    ds_read_b128 v[36:39], v24 offset:0
    ds_read_b64_tr_b16 v[40:41], v33 offset:0
    ds_read_b64_tr_b16 v[42:43], v33 offset:512
    v_mfma_f32_32x32x16_bf16 v[64:79], v[48:51], v[44:47], v[64:79]
    ds_read_b128 v[44:47], v25 offset:0
    ds_read_b64_tr_b16 v[48:49], v33 offset:2048
    ds_read_b64_tr_b16 v[50:51], v33 offset:2560
    s_waitcnt lgkmcnt(3)
    v_mfma_f32_32x32x16_bf16 v[64:79], v[40:43], v[36:39], v[64:79]
    ds_read_b128 v[36:39], v26 offset:0
    ds_read_b64_tr_b16 v[40:41], v33 offset:4096
    ds_read_b64_tr_b16 v[42:43], v33 offset:4608
    s_waitcnt lgkmcnt(3)
    v_mfma_f32_32x32x16_bf16 v[64:79], v[48:51], v[44:47], v[64:79]
    ds_read_b128 v[44:47], v27 offset:0
    ds_read_b64_tr_b16 v[48:49], v33 offset:6144
    ds_read_b64_tr_b16 v[50:51], v33 offset:6656
    s_waitcnt lgkmcnt(3)
    v_mfma_f32_32x32x16_bf16 v[64:79], v[40:43], v[36:39], v[64:79]
    ds_read_b128 v[36:39], v28 offset:0
    ds_read_b64_tr_b16 v[40:41], v33 offset:8192
    ds_read_b64_tr_b16 v[42:43], v33 offset:8704
    s_waitcnt lgkmcnt(3)
    v_mfma_f32_32x32x16_bf16 v[64:79], v[48:51], v[44:47], v[64:79]
    ds_read_b128 v[44:47], v29 offset:0
    ds_read_b64_tr_b16 v[48:49], v33 offset:10240
    ds_read_b64_tr_b16 v[50:51], v33 offset:10752
    s_waitcnt lgkmcnt(3)
    v_mfma_f32_32x32x16_bf16 v[64:79], v[40:43], v[36:39], v[64:79]
    ds_read_b128 v[36:39], v30 offset:0
    ds_read_b64_tr_b16 v[40:41], v33 offset:12288
    ds_read_b64_tr_b16 v[42:43], v33 offset:12800
    s_waitcnt lgkmcnt(3)
    v_mfma_f32_32x32x16_bf16 v[64:79], v[48:51], v[44:47], v[64:79]
    ds_read_b128 v[44:47], v31 offset:0
    ds_read_b64_tr_b16 v[48:49], v33 offset:14336
    ds_read_b64_tr_b16 v[50:51], v33 offset:14848
    s_waitcnt lgkmcnt(3)
    v_mfma_f32_32x32x16_bf16 v[64:79], v[40:43], v[36:39], v[64:79]
    v_add_u32 v24, s47, v16
    v_add_u32 v25, s47, v17
    v_add_u32 v26, s47, v18
    v_add_u32 v27, s47, v19
    v_add_u32 v28, s47, v20
    v_add_u32 v29, s47, v21
    v_add_u32 v30, s47, v22
    v_add_u32 v31, s47, v23
    v_add_u32 v33, s47, v32
    s_add_u32 s47, s47, 32768
    s_cmp_ge_u32 s47, 131072
    s_cselect_b32 s47, 0, s47
    s_waitcnt vmcnt(0) lgkmcnt(0)
    s_barrier
    ds_read_b128 v[36:39], v24 offset:0
    ds_read_b64_tr_b16 v[40:41], v33 offset:0
    ds_read_b64_tr_b16 v[42:43], v33 offset:512
    v_mfma_f32_32x32x16_bf16 v[64:79], v[48:51], v[44:47], v[64:79]
    ds_read_b128 v[44:47], v25 offset:0
    ds_read_b64_tr_b16 v[48:49], v33 offset:2048
    ds_read_b64_tr_b16 v[50:51], v33 offset:2560
    s_waitcnt lgkmcnt(3)
    v_mfma_f32_32x32x16_bf16 v[64:79], v[40:43], v[36:39], v[64:79]
    ds_read_b128 v[36:39], v26 offset:0
    ds_read_b64_tr_b16 v[40:41], v33 offset:4096
    ds_read_b64_tr_b16 v[42:43], v33 offset:4608
    s_waitcnt lgkmcnt(3)
    v_mfma_f32_32x32x16_bf16 v[64:79], v[48:51], v[44:47], v[64:79]
    ds_read_b128 v[44:47], v27 offset:0
    ds_read_b64_tr_b16 v[48:49], v33 offset:6144
    ds_read_b64_tr_b16 v[50:51], v33 offset:6656
    s_waitcnt lgkmcnt(3)
    v_mfma_f32_32x32x16_bf16 v[64:79], v[40:43], v[36:39], v[64:79]
    ds_read_b128 v[36:39], v28 offset:0
    ds_read_b64_tr_b16 v[40:41], v33 offset:8192
    ds_read_b64_tr_b16 v[42:43], v33 offset:8704
    s_waitcnt lgkmcnt(3)
    v_mfma_f32_32x32x16_bf16 v[64:79], v[48:51], v[44:47], v[64:79]
    ds_read_b128 v[44:47], v29 offset:0
    ds_read_b64_tr_b16 v[48:49], v33 offset:10240
    ds_read_b64_tr_b16 v[50:51], v33 offset:10752
    s_waitcnt lgkmcnt(3)
    v_mfma_f32_32x32x16_bf16 v[64:79], v[40:43], v[36:39], v[64:79]
    ds_read_b128 v[36:39], v30 offset:0
    ds_read_b64_tr_b16 v[40:41], v33 offset:12288
    ds_read_b64_tr_b16 v[42:43], v33 offset:12800
    s_waitcnt lgkmcnt(3)
    v_mfma_f32_32x32x16_bf16 v[64:79], v[48:51], v[44:47], v[64:79]
    ds_read_b128 v[44:47], v31 offset:0
    ds_read_b64_tr_b16 v[48:49], v33 offset:14336
    ds_read_b64_tr_b16 v[50:51], v33 offset:14848
    s_waitcnt lgkmcnt(3)
    v_mfma_f32_32x32x16_bf16 v[64:79], v[40:43], v[36:39], v[64:79]
    s_waitcnt lgkmcnt(0)
    v_mfma_f32_32x32x16_bf16 v[64:79], v[48:51], v[44:47], v[64:79]
    s_nop 15
    s_lshl_b32 s25, s23, 5
    v_add_u32 v10, s25, v5
    s_movk_i32 s25, 272
    v_mul_lo_u32 v10, v10, s25
    v_lshl_add_u32 v10, v7, 4, v10
    s_lshl_b32 s25, s24, 7
    v_add_u32 v10, s25, v10
    ds_write_b128 v10, v[64:67] offset:0
    ds_write_b128 v10, v[68:71] offset:32
    ds_write_b128 v10, v[72:75] offset:64
    ds_write_b128 v10, v[76:79] offset:96
    v_lshrrev_b32 v10, 3, v0
    s_movk_i32 s25, 272
    v_mul_lo_u32 v10, v10, s25
    v_lshl_add_u32 v10, v6, 5, v10
    s_waitcnt lgkmcnt(0)
    s_barrier
    ds_read_b128 v[64:67], v10 offset:0
    ds_read_b128 v[68:71], v10 offset:16
    ds_read_b128 v[72:75], v10 offset:8704
    ds_read_b128 v[76:79], v10 offset:8720
    s_waitcnt vmcnt(0) lgkmcnt(0)
    v_lshlrev_b32 v12, 16, v80
    v_and_b32 v13, 0xffff0000, v80
    v_add_f32 v64, v64, v12
    v_add_f32 v65, v65, v13
    v_lshlrev_b32 v12, 16, v81
    v_and_b32 v13, 0xffff0000, v81
    v_add_f32 v66, v66, v12
    v_add_f32 v67, v67, v13
    v_lshlrev_b32 v12, 16, v82
    v_and_b32 v13, 0xffff0000, v82
    v_add_f32 v68, v68, v12
    v_add_f32 v69, v69, v13
    v_lshlrev_b32 v12, 16, v83
    v_and_b32 v13, 0xffff0000, v83
    v_add_f32 v70, v70, v12
    v_add_f32 v71, v71, v13
    v_lshlrev_b32 v12, 16, v84
    v_and_b32 v13, 0xffff0000, v84
    v_add_f32 v72, v72, v12
    v_add_f32 v73, v73, v13
    v_lshlrev_b32 v12, 16, v85
    v_and_b32 v13, 0xffff0000, v85
    v_add_f32 v74, v74, v12
    v_add_f32 v75, v75, v13
    v_lshlrev_b32 v12, 16, v86
    v_and_b32 v13, 0xffff0000, v86
    v_add_f32 v76, v76, v12
    v_add_f32 v77, v77, v13
    v_lshlrev_b32 v12, 16, v87
    v_and_b32 v13, 0xffff0000, v87
    v_add_f32 v78, v78, v12
    v_add_f32 v79, v79, v13
    v_cvt_pk_bf16_f32 v64, v64, v65
    v_cvt_pk_bf16_f32 v65, v66, v67
    v_cvt_pk_bf16_f32 v66, v68, v69
    v_cvt_pk_bf16_f32 v67, v70, v71
    v_cvt_pk_bf16_f32 v68, v72, v73
    v_cvt_pk_bf16_f32 v69, v74, v75
    v_cvt_pk_bf16_f32 v70, v76, v77
    v_cvt_pk_bf16_f32 v71, v78, v79
    buffer_store_dwordx4 v[64:67], v3, s[8:11], s31 offen
    s_add_u32 s25, s31, 32768
    buffer_store_dwordx4 v[68:71], v3, s[8:11], s25 offen
L_down_kernel_end:
    s_endpgm
.section .rodata,"a"
.p2align 6
.amdhsa_kernel qkv_kernel
  .amdhsa_next_free_vgpr 128
  .amdhsa_next_free_sgpr 100
  .amdhsa_accum_offset 128
  .amdhsa_group_segment_fixed_size 0
  .amdhsa_kernarg_size 96
  .amdhsa_user_sgpr_count 2
  .amdhsa_user_sgpr_kernarg_segment_ptr 1
  .amdhsa_system_sgpr_workgroup_id_x 1
.end_amdhsa_kernel
.p2align 6
.amdhsa_kernel attn_kernel
  .amdhsa_next_free_vgpr 180
  .amdhsa_next_free_sgpr 100
  .amdhsa_accum_offset 180
  .amdhsa_group_segment_fixed_size 0
  .amdhsa_kernarg_size 96
  .amdhsa_user_sgpr_count 2
  .amdhsa_user_sgpr_kernarg_segment_ptr 1
  .amdhsa_system_sgpr_workgroup_id_x 1
.end_amdhsa_kernel
.p2align 6
.amdhsa_kernel wo_kernel
  .amdhsa_next_free_vgpr 112
  .amdhsa_next_free_sgpr 100
  .amdhsa_accum_offset 112
  .amdhsa_group_segment_fixed_size 0
  .amdhsa_kernarg_size 96
  .amdhsa_user_sgpr_count 2
  .amdhsa_user_sgpr_kernarg_segment_ptr 1
  .amdhsa_system_sgpr_workgroup_id_x 1
.end_amdhsa_kernel
.p2align 6
.amdhsa_kernel ffn_kernel
  .amdhsa_next_free_vgpr 192
  .amdhsa_next_free_sgpr 100
  .amdhsa_accum_offset 192
  .amdhsa_group_segment_fixed_size 0
  .amdhsa_kernarg_size 96
  .amdhsa_user_sgpr_count 2
  .amdhsa_user_sgpr_kernarg_segment_ptr 1
  .amdhsa_system_sgpr_workgroup_id_x 1
.end_amdhsa_kernel
.p2align 6
.amdhsa_kernel down_kernel
  .amdhsa_next_free_vgpr 112
  .amdhsa_next_free_sgpr 100
  .amdhsa_accum_offset 112
  .amdhsa_group_segment_fixed_size 0
  .amdhsa_kernarg_size 96
  .amdhsa_user_sgpr_count 2
  .amdhsa_user_sgpr_kernarg_segment_ptr 1
  .amdhsa_system_sgpr_workgroup_id_x 1
.end_amdhsa_kernel
```
